```python
import torch

def _softmax(x, axis=-1):
    return torch.softmax(x, dim=axis)
def _gelu(x):
    return torch.nn.functional.gelu(x, approximate="tanh")
def _silu(x):
    return torch.nn.functional.silu(x)
def _sigmoid(x):
    return torch.sigmoid(x)
def _layernorm(x, axis=-1, eps=1e-5):
    m = x.mean(dim=axis, keepdim=True)
    v = x.var(dim=axis, keepdim=True, unbiased=False)
    return (x - m) / torch.sqrt(v + eps)
def _scatter_add(tgt, idx, src, axis=0):
    return tgt.clone().index_add_(axis, idx, src)
def _segment_sum(src, seg, n):
    out = torch.zeros((n,) + src.shape[1:], dtype=src.dtype)
    return out.index_add_(0, seg, src)
def _pad(x, pw):
    flat = tuple(v for pair in reversed(pw) for v in pair)
    return torch.nn.functional.pad(x, flat)

kernel_name = 'gated_mix__grouped_kv_mqa__dense_activation_silu__prompt'

def setup_inputs():

    _w = (lambda a: (lambda t: t.to(torch.bfloat16) if t.is_floating_point() else t)(torch.as_tensor(a)))
    def _A_setup():
        B, S, D, H = 1, 2048, 512, 32
        Dh = D // H
        return {
            "x": _w((lambda *s: torch.randn(*s, dtype=torch.bfloat16) * 0.05)(B, S, D)),
            "wq": _w((lambda *s: torch.randn(*s, dtype=torch.bfloat16) * 0.8)(D, H * Dh)),
            "wk": _w((lambda *s: torch.randn(*s, dtype=torch.bfloat16) * 0.8)(D, Dh)),
            "wv": _w((lambda *s: torch.randn(*s, dtype=torch.bfloat16) * 0.05)(D, Dh)),
            "wo": _w((lambda *s: torch.randn(*s, dtype=torch.bfloat16) * 0.05)(H * Dh, D)),
        }
    _A_in = _A_setup()

    def _B_setup():
        B, S, D, F = 1, 2048, 512, 1792
        return {
            "x": _w((lambda *s: torch.randn(*s, dtype=torch.bfloat16) * 0.05)(B, S, D)),
            "w1": _w((lambda *s: torch.randn(*s, dtype=torch.bfloat16) * 3.2)(D, F) * (D ** -0.5)),
            "w2": _w((lambda *s: torch.randn(*s, dtype=torch.bfloat16) * 0.1)(F, D) * (F ** -0.5)),
        }
    _B_in = _B_setup()

    return {
        "A_x": _A_in["x"],
        "A_wq": _A_in["wq"],
        "A_wk": _A_in["wk"],
        "A_wv": _A_in["wv"],
        "A_wo": _A_in["wo"],
        "B_x": _B_in["x"],
        "B_w1": _B_in["w1"],
        "B_w2": _B_in["w2"],
        "gate_w": _w((lambda *s: torch.randn(*s, dtype=torch.bfloat16) * 0.05)(512) * 16.0),
    }

def reference(A_x, A_wq, A_wk, A_wv, A_wo, B_x, B_w1, B_w2, gate_w):
    def _A_ref(x, wq, wk, wv, wo):
        B, S, D = x.shape
        H = 32
        Dh = D // H
        q = (lambda x, *d: x.permute(*d))((x @ wq).reshape(B, S, H, Dh), 0, 2, 1, 3)
        k = x @ wk
        v = x @ wv
        scores = torch.einsum("bhqd,bkd->bhqk", q, k) * (Dh ** -0.5)
        p = _softmax(scores, axis=-1)
        o = torch.einsum("bhqk,bkd->bhqd", p, v)
        return (lambda x, *d: x.permute(*d))(o, 0, 2, 1, 3).reshape(B, S, H * Dh) @ wo

    def _B_ref(x, w1, w2):
        h = torch.einsum("bsd,df->bsf", x, w1)
        h = _silu(h)
        out = torch.einsum("bsf,fd->bsd", h, w2)
        return out

    x = A_x
    g = _sigmoid((x * gate_w).sum(-1, keepdims=True))
    a = _A_ref(x, A_wq, A_wk, A_wv, A_wo)
    b = _B_ref(x, B_w1, B_w2)
    return g * a + (1 - g) * b
```

```asm
; @launch grid=(512,1,1) block=(256,1,1) lds=81920
.amdgcn_target "amdgcn-amd-amdhsa--gfx950"
.text
.globl gated_mix__grouped_kv_mqa__dense_activation_silu__prompt_kernel
.p2align 8
.type gated_mix__grouped_kv_mqa__dense_activation_silu__prompt_kernel,@function
gated_mix__grouped_kv_mqa__dense_activation_silu__prompt_kernel:
    s_cmp_ge_u32 s2, 512
    s_cbranch_scc1 L_end
    s_load_dwordx16 s[4:19], s[0:1], 0
    s_load_dwordx8 s[20:27], s[0:1], 64
    v_lshrrev_b32 v1, 6, v0
    v_and_b32 v0, 63, v0
    s_getpc_b64 s[34:35]
L_pc:
    v_readfirstlane_b32 s28, v1
    s_lshr_b32 s3, s2, 3
    s_cmp_ge_u32 s3, 7
    s_cbranch_scc1 L_nopf
    s_lshl_b32 s3, s3, 2
    s_add_u32 s3, s3, s28
    s_min_u32 s3, s3, 27
    s_lshl_b32 s3, s3, 10
    v_lshl_add_u32 v1, v0, 4, s3
    global_load_dwordx4 v[236:239], v1, s[34:35]
L_nopf:
    s_and_b32 s3, s2, 255
    s_and_b32 s34, s3, 7
    s_lshr_b32 s35, s3, 3
    s_lshr_b32 s29, s34, 1
    s_lshl_b32 s29, s29, 3
    s_lshr_b32 s3, s35, 2
    s_add_u32 s29, s29, s3
    s_and_b32 s30, s34, 1
    s_lshl_b32 s30, s30, 2
    s_and_b32 s3, s35, 3
    s_add_u32 s30, s30, s3
    s_lshl_b32 s31, s29, 16
    s_mov_b32 s98, 0x0000ffff
    s_mov_b32 s99, 0x0000ffff
    s_waitcnt lgkmcnt(0)
    s_mov_b32 s52, s26
    s_mov_b32 s53, s27
    s_mov_b32 s54, 12582912
    s_mov_b32 s55, 0x00020000
    v_mov_b32 v253, 0
    buffer_load_dword v253, v253, s[52:55], 0 offen sc1
    s_cmp_lt_u32 s2, 256
    s_cbranch_scc1 L_A
L_G:
    s_mov_b32 s77, s35
    s_sub_u32 s74, s35, 28
    s_cmp_ge_u32 s35, 28
    s_cbranch_scc1 L_G_kv
    s_mul_i32 s3, s35, 37
    s_lshr_b32 s3, s3, 8
    s_mul_i32 s34, s3, 7
    s_cmp_lg_u32 s34, s35
    s_cbranch_scc1 L_G_ffn1
    s_add_u32 s74, s3, 4
L_G_kv:
    s_setprio 3
    s_mov_b32 s36, s4
    s_mov_b32 s37, s5
    s_mov_b32 s38, 2097152
    s_mov_b32 s39, 0x00020000
    s_mov_b32 s40, s8
    s_mov_b32 s41, s9
    s_mov_b32 s42, 16384
    s_mov_b32 s43, 0x00020000
    s_mov_b32 s44, s10
    s_mov_b32 s45, s11
    s_mov_b32 s46, 16384
    s_mov_b32 s47, 0x00020000
    s_mov_b32 s48, s20
    s_mov_b32 s49, s21
    s_mov_b32 s50, 1024
    s_mov_b32 s51, 0x00020000
    s_and_b32 s3, s2, 7
    s_lshl_b32 s79, s3, 3
    s_add_u32 s79, s79, s74
    v_lshlrev_b32 v1, 4, v0
    s_lshl_b32 s60, s79, 15
    s_lshl_b32 s3, s28, 13
    s_add_u32 s60, s60, s3
    s_mul_i32 s61, s28, 8320
    s_add_u32 m0, s61, 0
    s_add_u32 s3, s60, 0
    buffer_load_dwordx4 v1, s[36:39], s3 offen  lds
    s_add_u32 m0, s61, 1040
    s_add_u32 s3, s60, 1024
    buffer_load_dwordx4 v1, s[36:39], s3 offen  lds
    s_add_u32 m0, s61, 2080
    s_add_u32 s3, s60, 2048
    buffer_load_dwordx4 v1, s[36:39], s3 offen  lds
    s_add_u32 m0, s61, 3120
    s_add_u32 s3, s60, 3072
    buffer_load_dwordx4 v1, s[36:39], s3 offen  lds
    s_add_u32 m0, s61, 4160
    s_add_u32 s3, s60, 4096
    buffer_load_dwordx4 v1, s[36:39], s3 offen  lds
    s_add_u32 m0, s61, 5200
    s_add_u32 s3, s60, 5120
    buffer_load_dwordx4 v1, s[36:39], s3 offen  lds
    s_add_u32 m0, s61, 6240
    s_add_u32 s3, s60, 6144
    buffer_load_dwordx4 v1, s[36:39], s3 offen  lds
    s_add_u32 m0, s61, 7280
    s_add_u32 s3, s60, 7168
    buffer_load_dwordx4 v1, s[36:39], s3 offen  lds
    s_lshl_b32 s3, s28, 12
    s_add_u32 m0, s3, 33280
    s_nop 0
    buffer_load_dwordx4 v1, s[40:43], s3 offen offset:0 lds
    buffer_load_dwordx4 v1, s[40:43], s3 offen offset:1024 lds
    buffer_load_dwordx4 v1, s[40:43], s3 offen offset:2048 lds
    buffer_load_dwordx4 v1, s[40:43], s3 offen offset:3072 lds
    s_add_u32 m0, s3, 49664
    s_nop 0
    buffer_load_dwordx4 v1, s[44:47], s3 offen offset:0 lds
    buffer_load_dwordx4 v1, s[44:47], s3 offen offset:1024 lds
    buffer_load_dwordx4 v1, s[44:47], s3 offen offset:2048 lds
    buffer_load_dwordx4 v1, s[44:47], s3 offen offset:3072 lds
    s_cmp_lg_u32 s28, 2
    s_cbranch_scc1 L_nogate_1
    s_mov_b32 m0, 66048
    s_nop 0
    buffer_load_dwordx4 v1, s[48:51], 0 offen  lds
L_nogate_1:
    v_and_b32 v10, 31, v0
    v_lshrrev_b32 v11, 5, v0
    v_and_b32 v12, 15, v0
    v_and_b32 v13, 0x13, v10
    v_bfe_u32 v14, v10, 2, 1
    v_lshl_or_b32 v13, v14, 3, v13
    v_bfe_u32 v14, v10, 3, 1
    v_lshl_or_b32 v13, v14, 2, v13
    s_bitcmp1_b32 s28, 0
    s_cselect_b64 vcc, -1, 0
    s_movk_i32 s3, 1040
    s_lshr_b32 s65, s28, 1
    v_cndmask_b32 v13, v10, v13, vcc
    v_mul_lo_u32 v13, v13, s3
    v_lshl_add_u32 v5, v11, 4, v13
    s_lshl_b32 s3, s65, 9
    v_add_u32 v2, s3, v5
    s_mov_b32 s34, 33280
    s_bitcmp1_b32 s28, 0
    s_cselect_b32 s3, 49664, s34
    s_lshl_b32 s34, s65, 13
    s_add_u32 s3, s3, s34
    v_lshlrev_b32 v13, 8, v11
    v_lshl_add_u32 v13, v12, 3, v13
    v_add_u32 v3, s3, v13
    v_lshlrev_b32 v4, 4, v11
    v_add_u32 v4, 66048, v4
    s_and_b32 s3, s28, 1
    s_lshl_b32 s3, s3, 12
    s_add_u32 s3, s3, 67072
    v_add_u32 v6, s3, v1
    s_waitcnt vmcnt(0)
    s_barrier
    v_readfirstlane_b32 s32, v253
    s_nop 0
    s_add_u32 s32, s32, 1
    s_not_b32 s33, s32
    s_bitcmp1_b32 s28, 0
    s_cbranch_scc1 L_KV_v
    ds_read_b128 v[16:19], v2 offset:0
    ds_read_b64_tr_b16 v[20:21], v3 offset:0
    ds_read_b64_tr_b16 v[22:23], v3 offset:128
    ds_read_b128 v[24:27], v2 offset:32
    ds_read_b64_tr_b16 v[28:29], v3 offset:512
    ds_read_b64_tr_b16 v[30:31], v3 offset:640
    ds_read_b128 v[32:35], v2 offset:64
    ds_read_b64_tr_b16 v[36:37], v3 offset:1024
    ds_read_b64_tr_b16 v[38:39], v3 offset:1152
    ds_read_b128 v[40:43], v2 offset:96
    ds_read_b64_tr_b16 v[44:45], v3 offset:1536
    ds_read_b64_tr_b16 v[46:47], v3 offset:1664
    s_waitcnt lgkmcnt(9)
    v_mfma_f32_32x32x16_bf16 v[64:79], v[20:23], v[16:19], 0
    ds_read_b128 v[16:19], v2 offset:128
    ds_read_b64_tr_b16 v[20:21], v3 offset:2048
    ds_read_b64_tr_b16 v[22:23], v3 offset:2176
    s_waitcnt lgkmcnt(9)
    v_mfma_f32_32x32x16_bf16 v[64:79], v[28:31], v[24:27], v[64:79]
    ds_read_b128 v[24:27], v2 offset:160
    ds_read_b64_tr_b16 v[28:29], v3 offset:2560
    ds_read_b64_tr_b16 v[30:31], v3 offset:2688
    s_waitcnt lgkmcnt(9)
    v_mfma_f32_32x32x16_bf16 v[64:79], v[36:39], v[32:35], v[64:79]
    ds_read_b128 v[32:35], v2 offset:192
    ds_read_b64_tr_b16 v[36:37], v3 offset:3072
    ds_read_b64_tr_b16 v[38:39], v3 offset:3200
    s_waitcnt lgkmcnt(9)
    v_mfma_f32_32x32x16_bf16 v[64:79], v[44:47], v[40:43], v[64:79]
    ds_read_b128 v[40:43], v2 offset:224
    ds_read_b64_tr_b16 v[44:45], v3 offset:3584
    ds_read_b64_tr_b16 v[46:47], v3 offset:3712
    s_waitcnt lgkmcnt(9)
    v_mfma_f32_32x32x16_bf16 v[64:79], v[20:23], v[16:19], v[64:79]
    ds_read_b128 v[16:19], v2 offset:256
    ds_read_b64_tr_b16 v[20:21], v3 offset:4096
    ds_read_b64_tr_b16 v[22:23], v3 offset:4224
    s_waitcnt lgkmcnt(9)
    v_mfma_f32_32x32x16_bf16 v[64:79], v[28:31], v[24:27], v[64:79]
    ds_read_b128 v[24:27], v2 offset:288
    ds_read_b64_tr_b16 v[28:29], v3 offset:4608
    ds_read_b64_tr_b16 v[30:31], v3 offset:4736
    s_waitcnt lgkmcnt(9)
    v_mfma_f32_32x32x16_bf16 v[64:79], v[36:39], v[32:35], v[64:79]
    ds_read_b128 v[32:35], v2 offset:320
    ds_read_b64_tr_b16 v[36:37], v3 offset:5120
    ds_read_b64_tr_b16 v[38:39], v3 offset:5248
    s_waitcnt lgkmcnt(9)
    v_mfma_f32_32x32x16_bf16 v[64:79], v[44:47], v[40:43], v[64:79]
    ds_read_b128 v[40:43], v2 offset:352
    ds_read_b64_tr_b16 v[44:45], v3 offset:5632
    ds_read_b64_tr_b16 v[46:47], v3 offset:5760
    s_waitcnt lgkmcnt(9)
    v_mfma_f32_32x32x16_bf16 v[64:79], v[20:23], v[16:19], v[64:79]
    ds_read_b128 v[16:19], v2 offset:384
    ds_read_b64_tr_b16 v[20:21], v3 offset:6144
    ds_read_b64_tr_b16 v[22:23], v3 offset:6272
    s_waitcnt lgkmcnt(9)
    v_mfma_f32_32x32x16_bf16 v[64:79], v[28:31], v[24:27], v[64:79]
    ds_read_b128 v[24:27], v2 offset:416
    ds_read_b64_tr_b16 v[28:29], v3 offset:6656
    ds_read_b64_tr_b16 v[30:31], v3 offset:6784
    s_waitcnt lgkmcnt(9)
    v_mfma_f32_32x32x16_bf16 v[64:79], v[36:39], v[32:35], v[64:79]
    ds_read_b128 v[32:35], v2 offset:448
    ds_read_b64_tr_b16 v[36:37], v3 offset:7168
    ds_read_b64_tr_b16 v[38:39], v3 offset:7296
    s_waitcnt lgkmcnt(9)
    v_mfma_f32_32x32x16_bf16 v[64:79], v[44:47], v[40:43], v[64:79]
    ds_read_b128 v[40:43], v2 offset:480
    ds_read_b64_tr_b16 v[44:45], v3 offset:7680
    ds_read_b64_tr_b16 v[46:47], v3 offset:7808
    s_waitcnt lgkmcnt(9)
    v_mfma_f32_32x32x16_bf16 v[64:79], v[20:23], v[16:19], v[64:79]
    s_waitcnt lgkmcnt(6)
    v_mfma_f32_32x32x16_bf16 v[64:79], v[28:31], v[24:27], v[64:79]
    s_waitcnt lgkmcnt(3)
    v_mfma_f32_32x32x16_bf16 v[64:79], v[36:39], v[32:35], v[64:79]
    s_waitcnt lgkmcnt(0)
    v_mfma_f32_32x32x16_bf16 v[64:79], v[44:47], v[40:43], v[64:79]
    s_nop 11
    s_cmp_eq_u32 s65, 0
    s_cbranch_scc1 L_xlo_2
    ds_write_b128 v6, v[64:67] offset:0
    ds_write_b128 v6, v[68:71] offset:1024
    s_waitcnt lgkmcnt(0)
    s_barrier
    s_branch L_KV_g
L_xlo_2:
    s_barrier
    ds_read_b128 v[16:19], v6 offset:0
    ds_read_b128 v[20:23], v6 offset:1024
    s_waitcnt lgkmcnt(0)
    v_add_f32 v64, v64, v16
    v_add_f32 v65, v65, v17
    v_add_f32 v66, v66, v18
    v_add_f32 v67, v67, v19
    v_add_f32 v68, v68, v20
    v_add_f32 v69, v69, v21
    v_add_f32 v70, v70, v22
    v_add_f32 v71, v71, v23
    v_mul_f32 v64, 0x3eb8aa3b, v64
    v_mul_f32 v65, 0x3eb8aa3b, v65
    v_mul_f32 v66, 0x3eb8aa3b, v66
    v_mul_f32 v67, 0x3eb8aa3b, v67
    v_mul_f32 v68, 0x3eb8aa3b, v68
    v_mul_f32 v69, 0x3eb8aa3b, v69
    v_mul_f32 v70, 0x3eb8aa3b, v70
    v_mul_f32 v71, 0x3eb8aa3b, v71
    v_cvt_pk_bf16_f32 v24, v64, v65
    v_cvt_pk_bf16_f32 v25, v66, v67
    v_cvt_pk_bf16_f32 v26, v68, v69
    v_cvt_pk_bf16_f32 v27, v70, v71
    s_lshl_b32 s3, s79, 10
    s_add_u32 s3, s3, 65536
    buffer_store_dwordx4 v[24:27], v1, s[52:55], s3 offen sc1
    v_mul_f32 v8, v64, v64
    v_fmac_f32 v8, v65, v65
    v_fmac_f32 v8, v66, v66
    v_fmac_f32 v8, v67, v67
    v_fmac_f32 v8, v68, v68
    v_fmac_f32 v8, v69, v69
    v_fmac_f32 v8, v70, v70
    v_fmac_f32 v8, v71, v71
    v_mov_b32 v9, v8
    v_mov_b32 v15, v8
    s_nop 1
    v_permlane32_swap_b32 v9, v15
    v_add_f32 v8, v9, v15
    v_mul_f32 v8, 0x3f828f5c, v8
    s_nop 1
    v_max_f32_dpp v8, v8, v8 row_ror:8 row_mask:0xf bank_mask:0xf
    s_nop 1
    v_max_f32_dpp v8, v8, v8 row_ror:4 row_mask:0xf bank_mask:0xf
    s_nop 1
    v_max_f32_dpp v8, v8, v8 row_ror:2 row_mask:0xf bank_mask:0xf
    s_nop 1
    v_max_f32_dpp v8, v8, v8 row_ror:1 row_mask:0xf bank_mask:0xf
    s_nop 1
    v_readlane_b32 s63, v8, 0
    v_readlane_b32 s3, v8, 16
    s_nop 1
    s_max_u32 s63, s63, s3
    s_lshl_b32 s64, s79, 5
    s_add_u32 s64, s64, 4096
    s_branch L_KV_flag
L_KV_v:
    ds_read_b128 v[16:19], v2 offset:0
    ds_read_b64_tr_b16 v[20:21], v3 offset:0
    ds_read_b64_tr_b16 v[22:23], v3 offset:128
    ds_read_b128 v[24:27], v2 offset:32
    ds_read_b64_tr_b16 v[28:29], v3 offset:512
    ds_read_b64_tr_b16 v[30:31], v3 offset:640
    ds_read_b128 v[32:35], v2 offset:64
    ds_read_b64_tr_b16 v[36:37], v3 offset:1024
    ds_read_b64_tr_b16 v[38:39], v3 offset:1152
    ds_read_b128 v[40:43], v2 offset:96
    ds_read_b64_tr_b16 v[44:45], v3 offset:1536
    ds_read_b64_tr_b16 v[46:47], v3 offset:1664
    s_waitcnt lgkmcnt(9)
    v_mfma_f32_32x32x16_bf16 v[64:79], v[16:19], v[20:23], 0
    ds_read_b128 v[16:19], v2 offset:128
    ds_read_b64_tr_b16 v[20:21], v3 offset:2048
    ds_read_b64_tr_b16 v[22:23], v3 offset:2176
    s_waitcnt lgkmcnt(9)
    v_mfma_f32_32x32x16_bf16 v[64:79], v[24:27], v[28:31], v[64:79]
    ds_read_b128 v[24:27], v2 offset:160
    ds_read_b64_tr_b16 v[28:29], v3 offset:2560
    ds_read_b64_tr_b16 v[30:31], v3 offset:2688
    s_waitcnt lgkmcnt(9)
    v_mfma_f32_32x32x16_bf16 v[64:79], v[32:35], v[36:39], v[64:79]
    ds_read_b128 v[32:35], v2 offset:192
    ds_read_b64_tr_b16 v[36:37], v3 offset:3072
    ds_read_b64_tr_b16 v[38:39], v3 offset:3200
    s_waitcnt lgkmcnt(9)
    v_mfma_f32_32x32x16_bf16 v[64:79], v[40:43], v[44:47], v[64:79]
    ds_read_b128 v[40:43], v2 offset:224
    ds_read_b64_tr_b16 v[44:45], v3 offset:3584
    ds_read_b64_tr_b16 v[46:47], v3 offset:3712
    s_waitcnt lgkmcnt(9)
    v_mfma_f32_32x32x16_bf16 v[64:79], v[16:19], v[20:23], v[64:79]
    ds_read_b128 v[16:19], v2 offset:256
    ds_read_b64_tr_b16 v[20:21], v3 offset:4096
    ds_read_b64_tr_b16 v[22:23], v3 offset:4224
    s_waitcnt lgkmcnt(9)
    v_mfma_f32_32x32x16_bf16 v[64:79], v[24:27], v[28:31], v[64:79]
    ds_read_b128 v[24:27], v2 offset:288
    ds_read_b64_tr_b16 v[28:29], v3 offset:4608
    ds_read_b64_tr_b16 v[30:31], v3 offset:4736
    s_waitcnt lgkmcnt(9)
    v_mfma_f32_32x32x16_bf16 v[64:79], v[32:35], v[36:39], v[64:79]
    ds_read_b128 v[32:35], v2 offset:320
    ds_read_b64_tr_b16 v[36:37], v3 offset:5120
    ds_read_b64_tr_b16 v[38:39], v3 offset:5248
    s_waitcnt lgkmcnt(9)
    v_mfma_f32_32x32x16_bf16 v[64:79], v[40:43], v[44:47], v[64:79]
    ds_read_b128 v[40:43], v2 offset:352
    ds_read_b64_tr_b16 v[44:45], v3 offset:5632
    ds_read_b64_tr_b16 v[46:47], v3 offset:5760
    s_waitcnt lgkmcnt(9)
    v_mfma_f32_32x32x16_bf16 v[64:79], v[16:19], v[20:23], v[64:79]
    ds_read_b128 v[16:19], v2 offset:384
    ds_read_b64_tr_b16 v[20:21], v3 offset:6144
    ds_read_b64_tr_b16 v[22:23], v3 offset:6272
    s_waitcnt lgkmcnt(9)
    v_mfma_f32_32x32x16_bf16 v[64:79], v[24:27], v[28:31], v[64:79]
    ds_read_b128 v[24:27], v2 offset:416
    ds_read_b64_tr_b16 v[28:29], v3 offset:6656
    ds_read_b64_tr_b16 v[30:31], v3 offset:6784
    s_waitcnt lgkmcnt(9)
    v_mfma_f32_32x32x16_bf16 v[64:79], v[32:35], v[36:39], v[64:79]
    ds_read_b128 v[32:35], v2 offset:448
    ds_read_b64_tr_b16 v[36:37], v3 offset:7168
    ds_read_b64_tr_b16 v[38:39], v3 offset:7296
    s_waitcnt lgkmcnt(9)
    v_mfma_f32_32x32x16_bf16 v[64:79], v[40:43], v[44:47], v[64:79]
    ds_read_b128 v[40:43], v2 offset:480
    ds_read_b64_tr_b16 v[44:45], v3 offset:7680
    ds_read_b64_tr_b16 v[46:47], v3 offset:7808
    s_waitcnt lgkmcnt(9)
    v_mfma_f32_32x32x16_bf16 v[64:79], v[16:19], v[20:23], v[64:79]
    s_waitcnt lgkmcnt(6)
    v_mfma_f32_32x32x16_bf16 v[64:79], v[24:27], v[28:31], v[64:79]
    s_waitcnt lgkmcnt(3)
    v_mfma_f32_32x32x16_bf16 v[64:79], v[32:35], v[36:39], v[64:79]
    s_waitcnt lgkmcnt(0)
    v_mfma_f32_32x32x16_bf16 v[64:79], v[40:43], v[44:47], v[64:79]
    s_nop 11
    s_cmp_eq_u32 s65, 0
    s_cbranch_scc1 L_xlo_3
    ds_write_b128 v6, v[64:67] offset:0
    ds_write_b128 v6, v[68:71] offset:1024
    ds_write_b128 v6, v[72:75] offset:2048
    ds_write_b128 v6, v[76:79] offset:3072
    s_waitcnt lgkmcnt(0)
    s_barrier
    s_branch L_KV_end
L_xlo_3:
    s_barrier
    ds_read_b128 v[16:19], v6 offset:0
    ds_read_b128 v[20:23], v6 offset:1024
    ds_read_b128 v[24:27], v6 offset:2048
    ds_read_b128 v[28:31], v6 offset:3072
    s_waitcnt lgkmcnt(0)
    v_add_f32 v64, v64, v16
    v_add_f32 v65, v65, v17
    v_add_f32 v66, v66, v18
    v_add_f32 v67, v67, v19
    v_add_f32 v68, v68, v20
    v_add_f32 v69, v69, v21
    v_add_f32 v70, v70, v22
    v_add_f32 v71, v71, v23
    v_add_f32 v72, v72, v24
    v_add_f32 v73, v73, v25
    v_add_f32 v74, v74, v26
    v_add_f32 v75, v75, v27
    v_add_f32 v76, v76, v28
    v_add_f32 v77, v77, v29
    v_add_f32 v78, v78, v30
    v_add_f32 v79, v79, v31
    v_max3_f32 v8, |v64|, |v65|, |v66|
    v_max3_f32 v8, v8, |v67|, |v68|
    v_max3_f32 v8, v8, |v69|, |v70|
    v_max3_f32 v8, v8, |v71|, |v72|
    v_max3_f32 v8, v8, |v73|, |v74|
    v_max3_f32 v8, v8, |v75|, |v76|
    v_max3_f32 v8, v8, |v77|, |v78|
    v_max_f32 v8, v8, |v79|
    v_cvt_pk_bf16_f32 v24, v64, v65
    v_cvt_pk_bf16_f32 v25, v66, v67
    v_cvt_pk_bf16_f32 v26, v68, v69
    v_cvt_pk_bf16_f32 v27, v70, v71
    v_cvt_pk_bf16_f32 v28, v72, v73
    v_cvt_pk_bf16_f32 v29, v74, v75
    v_cvt_pk_bf16_f32 v30, v76, v77
    v_cvt_pk_bf16_f32 v31, v78, v79
    v_cmp_nge_f32 vcc, 0x5d800000, v8
    v_lshlrev_b32 v9, 8, v11
    v_lshl_add_u32 v9, v12, 4, v9
    s_lshl_b32 s3, s79, 10
    s_add_u32 s3, s3, 131072
    s_cmp_lg_u64 vcc, 0
    s_cselect_b32 s63, 1, 0
    s_mov_b64 exec, s[98:99]
    buffer_store_dwordx4 v[24:27], v9, s[52:55], s3 offen sc1
    buffer_store_dwordx4 v[28:31], v9, s[52:55], s3 offen offset:512 sc1
    s_mov_b64 exec, -1
    s_lshl_b32 s64, s79, 5
    s_add_u32 s64, s64, 4104
    s_branch L_KV_flag
L_KV_g:
    s_setprio 0
    ds_read_b128 v[16:19], v5 offset:0
    ds_read_b128 v[20:23], v4 offset:0
    ds_read_b128 v[24:27], v5 offset:32
    ds_read_b128 v[28:31], v4 offset:32
    ds_read_b128 v[32:35], v5 offset:64
    ds_read_b128 v[36:39], v4 offset:64
    ds_read_b128 v[40:43], v5 offset:96
    ds_read_b128 v[44:47], v4 offset:96
    s_waitcnt lgkmcnt(6)
    v_mfma_f32_32x32x16_bf16 v[64:79], v[20:23], v[16:19], 0
    ds_read_b128 v[16:19], v5 offset:128
    ds_read_b128 v[20:23], v4 offset:128
    s_waitcnt lgkmcnt(6)
    v_mfma_f32_32x32x16_bf16 v[64:79], v[28:31], v[24:27], v[64:79]
    ds_read_b128 v[24:27], v5 offset:160
    ds_read_b128 v[28:31], v4 offset:160
    s_waitcnt lgkmcnt(6)
    v_mfma_f32_32x32x16_bf16 v[64:79], v[36:39], v[32:35], v[64:79]
    ds_read_b128 v[32:35], v5 offset:192
    ds_read_b128 v[36:39], v4 offset:192
    s_waitcnt lgkmcnt(6)
    v_mfma_f32_32x32x16_bf16 v[64:79], v[44:47], v[40:43], v[64:79]
    ds_read_b128 v[40:43], v5 offset:224
    ds_read_b128 v[44:47], v4 offset:224
    s_waitcnt lgkmcnt(6)
    v_mfma_f32_32x32x16_bf16 v[64:79], v[20:23], v[16:19], v[64:79]
    ds_read_b128 v[16:19], v5 offset:256
    ds_read_b128 v[20:23], v4 offset:256
    s_waitcnt lgkmcnt(6)
    v_mfma_f32_32x32x16_bf16 v[64:79], v[28:31], v[24:27], v[64:79]
    ds_read_b128 v[24:27], v5 offset:288
    ds_read_b128 v[28:31], v4 offset:288
    s_waitcnt lgkmcnt(6)
    v_mfma_f32_32x32x16_bf16 v[64:79], v[36:39], v[32:35], v[64:79]
    ds_read_b128 v[32:35], v5 offset:320
    ds_read_b128 v[36:39], v4 offset:320
    s_waitcnt lgkmcnt(6)
    v_mfma_f32_32x32x16_bf16 v[64:79], v[44:47], v[40:43], v[64:79]
    ds_read_b128 v[40:43], v5 offset:352
    ds_read_b128 v[44:47], v4 offset:352
    s_waitcnt lgkmcnt(6)
    v_mfma_f32_32x32x16_bf16 v[64:79], v[20:23], v[16:19], v[64:79]
    ds_read_b128 v[16:19], v5 offset:384
    ds_read_b128 v[20:23], v4 offset:384
    s_waitcnt lgkmcnt(6)
    v_mfma_f32_32x32x16_bf16 v[64:79], v[28:31], v[24:27], v[64:79]
    ds_read_b128 v[24:27], v5 offset:416
    ds_read_b128 v[28:31], v4 offset:416
    s_waitcnt lgkmcnt(6)
    v_mfma_f32_32x32x16_bf16 v[64:79], v[36:39], v[32:35], v[64:79]
    ds_read_b128 v[32:35], v5 offset:448
    ds_read_b128 v[36:39], v4 offset:448
    s_waitcnt lgkmcnt(6)
    v_mfma_f32_32x32x16_bf16 v[64:79], v[44:47], v[40:43], v[64:79]
    ds_read_b128 v[40:43], v5 offset:480
    ds_read_b128 v[44:47], v4 offset:480
    s_waitcnt lgkmcnt(6)
    v_mfma_f32_32x32x16_bf16 v[64:79], v[20:23], v[16:19], v[64:79]
    ds_read_b128 v[16:19], v5 offset:512
    ds_read_b128 v[20:23], v4 offset:512
    s_waitcnt lgkmcnt(6)
    v_mfma_f32_32x32x16_bf16 v[64:79], v[28:31], v[24:27], v[64:79]
    ds_read_b128 v[24:27], v5 offset:544
    ds_read_b128 v[28:31], v4 offset:544
    s_waitcnt lgkmcnt(6)
    v_mfma_f32_32x32x16_bf16 v[64:79], v[36:39], v[32:35], v[64:79]
    ds_read_b128 v[32:35], v5 offset:576
    ds_read_b128 v[36:39], v4 offset:576
    s_waitcnt lgkmcnt(6)
    v_mfma_f32_32x32x16_bf16 v[64:79], v[44:47], v[40:43], v[64:79]
    ds_read_b128 v[40:43], v5 offset:608
    ds_read_b128 v[44:47], v4 offset:608
    s_waitcnt lgkmcnt(6)
    v_mfma_f32_32x32x16_bf16 v[64:79], v[20:23], v[16:19], v[64:79]
    ds_read_b128 v[16:19], v5 offset:640
    ds_read_b128 v[20:23], v4 offset:640
    s_waitcnt lgkmcnt(6)
    v_mfma_f32_32x32x16_bf16 v[64:79], v[28:31], v[24:27], v[64:79]
    ds_read_b128 v[24:27], v5 offset:672
    ds_read_b128 v[28:31], v4 offset:672
    s_waitcnt lgkmcnt(6)
    v_mfma_f32_32x32x16_bf16 v[64:79], v[36:39], v[32:35], v[64:79]
    ds_read_b128 v[32:35], v5 offset:704
    ds_read_b128 v[36:39], v4 offset:704
    s_waitcnt lgkmcnt(6)
    v_mfma_f32_32x32x16_bf16 v[64:79], v[44:47], v[40:43], v[64:79]
    ds_read_b128 v[40:43], v5 offset:736
    ds_read_b128 v[44:47], v4 offset:736
    s_waitcnt lgkmcnt(6)
    v_mfma_f32_32x32x16_bf16 v[64:79], v[20:23], v[16:19], v[64:79]
    ds_read_b128 v[16:19], v5 offset:768
    ds_read_b128 v[20:23], v4 offset:768
    s_waitcnt lgkmcnt(6)
    v_mfma_f32_32x32x16_bf16 v[64:79], v[28:31], v[24:27], v[64:79]
    ds_read_b128 v[24:27], v5 offset:800
    ds_read_b128 v[28:31], v4 offset:800
    s_waitcnt lgkmcnt(6)
    v_mfma_f32_32x32x16_bf16 v[64:79], v[36:39], v[32:35], v[64:79]
    ds_read_b128 v[32:35], v5 offset:832
    ds_read_b128 v[36:39], v4 offset:832
    s_waitcnt lgkmcnt(6)
    v_mfma_f32_32x32x16_bf16 v[64:79], v[44:47], v[40:43], v[64:79]
    ds_read_b128 v[40:43], v5 offset:864
    ds_read_b128 v[44:47], v4 offset:864
    s_waitcnt lgkmcnt(6)
    v_mfma_f32_32x32x16_bf16 v[64:79], v[20:23], v[16:19], v[64:79]
    ds_read_b128 v[16:19], v5 offset:896
    ds_read_b128 v[20:23], v4 offset:896
    s_waitcnt lgkmcnt(6)
    v_mfma_f32_32x32x16_bf16 v[64:79], v[28:31], v[24:27], v[64:79]
    ds_read_b128 v[24:27], v5 offset:928
    ds_read_b128 v[28:31], v4 offset:928
    s_waitcnt lgkmcnt(6)
    v_mfma_f32_32x32x16_bf16 v[64:79], v[36:39], v[32:35], v[64:79]
    ds_read_b128 v[32:35], v5 offset:960
    ds_read_b128 v[36:39], v4 offset:960
    s_waitcnt lgkmcnt(6)
    v_mfma_f32_32x32x16_bf16 v[64:79], v[44:47], v[40:43], v[64:79]
    ds_read_b128 v[40:43], v5 offset:992
    ds_read_b128 v[44:47], v4 offset:992
    s_waitcnt lgkmcnt(6)
    v_mfma_f32_32x32x16_bf16 v[64:79], v[20:23], v[16:19], v[64:79]
    s_waitcnt lgkmcnt(4)
    v_mfma_f32_32x32x16_bf16 v[64:79], v[28:31], v[24:27], v[64:79]
    s_waitcnt lgkmcnt(2)
    v_mfma_f32_32x32x16_bf16 v[64:79], v[36:39], v[32:35], v[64:79]
    s_waitcnt lgkmcnt(0)
    v_mfma_f32_32x32x16_bf16 v[64:79], v[44:47], v[40:43], v[64:79]
    s_nop 11
    v_mul_f32 v8, 0xbfb8aa3b, v64
    v_exp_f32 v8, v8
    v_lshlrev_b32 v9, 2, v10
    s_lshl_b32 s3, s79, 7
    v_add_f32 v8, 1.0, v8
    v_rcp_f32 v8, v8
    s_add_u32 s3, s3, 24576
    s_mov_b32 exec_hi, 0
    buffer_store_dword v8, v9, s[52:55], s3 offen sc1
    s_mov_b32 exec_hi, -1
    s_lshl_b32 s64, s79, 3
    s_add_u32 s64, s64, 12288
    s_waitcnt vmcnt(0)
    v_mov_b32 v32, s32
    v_mov_b32 v33, s33
    s_mov_b64 exec, 1
    buffer_store_dwordx2 v[32:33], off, s[52:55], s64 sc1
    s_mov_b64 exec, -1
    s_branch L_KV_end
L_KV_flag:
    v_mov_b32 v32, s32
    v_mov_b32 v33, s63
    v_mov_b32 v9, 0
    s_waitcnt vmcnt(0)
    s_mov_b64 exec, 1
    buffer_store_dwordx2 v[32:33], v9, s[52:55], s64 offen sc1
    s_mov_b64 exec, -1
L_KV_end:
    s_barrier
    s_mov_b32 s35, s77
    s_cmp_ge_u32 s35, 28
    s_cbranch_scc1 L_G_ffn2
L_G_ffn1:
    s_setprio 1
    s_mov_b32 s36, s4
    s_mov_b32 s37, s5
    s_mov_b32 s38, 2097152
    s_mov_b32 s39, 0x00020000
    s_mov_b32 s40, s16
    s_mov_b32 s41, s17
    s_mov_b32 s42, 1835008
    s_mov_b32 s43, 0x00020000
    s_mul_i32 s3, s35, 37
    s_lshr_b32 s3, s3, 8
    s_mul_i32 s34, s3, 7
    s_sub_u32 s77, s35, s34
    s_and_b32 s34, s2, 7
    s_lshr_b32 s76, s34, 1
    s_lshl_b32 s76, s76, 2
    s_add_u32 s76, s76, s3
    s_and_b32 s34, s34, 1
    s_mul_i32 s34, s34, 7
    s_add_u32 s77, s77, s34
    v_lshrrev_b32 v10, 3, v0
    v_lshlrev_b32 v10, 10, v10
    v_and_b32 v11, 7, v0
    v_lshrrev_b32 v12, 4, v0
    v_xor_b32 v13, v11, v12
    v_lshl_add_u32 v3, v13, 4, v10
    v_xor_b32 v13, 4, v13
    v_lshl_add_u32 v4, v13, 4, v10
    v_add_u32 v4, 7168, v4
    v_and_b32 v11, 15, v0
    v_lshlrev_b32 v13, 2, v12
    v_xor_b32 v11, v11, v13
    v_mul_u32_u24 v12, 3584, v12
    v_lshl_add_u32 v1, v11, 4, v12
    v_add_u32 v2, 13312, v1
    s_lshl_b32 s60, s76, 17
    s_lshl_b32 s3, s28, 14
    s_add_u32 s60, s60, s3
    s_lshl_b32 s61, s77, 8
    s_mul_i32 s3, s28, 28672
    s_add_u32 s61, s61, s3
    s_lshl_b32 s62, s28, 11
    s_add_u32 m0, s62, 32768
    s_add_u32 s3, s60, 0
    buffer_load_dwordx4 v3, s[36:39], s3 offen lds
    buffer_load_dwordx4 v4, s[36:39], s3 offen offset:1024 lds
    s_add_u32 m0, s62, 40960
    s_add_u32 s3, s60, 65536
    buffer_load_dwordx4 v3, s[36:39], s3 offen lds
    buffer_load_dwordx4 v4, s[36:39], s3 offen offset:1024 lds
    s_add_u32 m0, s62, 0
    s_add_u32 s3, s61, 0
    buffer_load_dwordx4 v1, s[40:43], s3 offen lds
    buffer_load_dwordx4 v2, s[40:43], s3 offen offset:1024 lds
    s_add_u32 m0, s62, 49152
    s_add_u32 s3, s60, 128
    buffer_load_dwordx4 v3, s[36:39], s3 offen lds
    buffer_load_dwordx4 v4, s[36:39], s3 offen offset:1024 lds
    s_add_u32 m0, s62, 8192
    s_add_u32 s3, s61, 114688
    buffer_load_dwordx4 v1, s[40:43], s3 offen lds
    buffer_load_dwordx4 v2, s[40:43], s3 offen offset:1024 lds
    s_add_u32 m0, s62, 57344
    s_add_u32 s3, s60, 65664
    buffer_load_dwordx4 v3, s[36:39], s3 offen lds
    buffer_load_dwordx4 v4, s[36:39], s3 offen offset:1024 lds
    s_add_u32 m0, s62, 16384
    s_add_u32 s3, s61, 229376
    buffer_load_dwordx4 v1, s[40:43], s3 offen lds
    buffer_load_dwordx4 v2, s[40:43], s3 offen offset:1024 lds
    s_add_u32 m0, s62, 65536
    s_add_u32 s3, s60, 256
    buffer_load_dwordx4 v3, s[36:39], s3 offen lds
    buffer_load_dwordx4 v4, s[36:39], s3 offen offset:1024 lds
    s_add_u32 m0, s62, 24576
    s_add_u32 s3, s61, 344064
    buffer_load_dwordx4 v1, s[40:43], s3 offen lds
    buffer_load_dwordx4 v2, s[40:43], s3 offen offset:1024 lds
    s_lshr_b32 s3, s2, 3
    s_lshl_b32 s3, s3, 2
    s_add_u32 s68, s3, s28
    s_cmp_ge_u32 s68, 208
    s_cbranch_scc1 L_pfd_6
    s_cmp_ge_u32 s68, 96
    s_cbranch_scc1 L_pfw1_4
    s_cmp_ge_u32 s68, 64
    s_cbranch_scc1 L_pfwq_5
    s_lshr_b32 s3, s29, 3
    s_lshl_b32 s3, s3, 19
    s_lshl_b32 s34, s68, 13
    s_add_u32 s3, s3, s34
    v_lshlrev_b32 v249, 7, v0
    s_mov_b32 s48, s4
    s_mov_b32 s49, s5
    s_mov_b32 s50, 2097152
    s_mov_b32 s51, 0x00020000
    buffer_load_dword v248, v249, s[48:51], s3 offen
    s_branch L_pfd_6
L_pfwq_5:
    s_sub_u32 s3, s68, 64
    s_lshl_b32 s3, s3, 14
    s_lshr_b32 s34, s30, 2
    s_lshl_b32 s34, s34, 9
    s_add_u32 s3, s3, s34
    v_lshrrev_b32 v249, 2, v0
    v_lshlrev_b32 v249, 10, v249
    v_and_b32 v250, 3, v0
    v_lshl_add_u32 v249, v250, 7, v249
    s_mov_b32 s48, s6
    s_mov_b32 s49, s7
    s_mov_b32 s50, 524288
    s_mov_b32 s51, 0x00020000
    buffer_load_dword v248, v249, s[48:51], s3 offen
    s_branch L_pfd_6
L_pfw1_4:
    s_sub_u32 s3, s68, 96
    s_lshl_b32 s3, s3, 6
    v_add_u32 v249, s3, v0
    s_mov_b32 s34, 37450
    v_mul_lo_u32 v250, v249, s34
    v_lshrrev_b32 v250, 19, v250
    v_mul_u32_u24 v251, 14, v250
    v_sub_u32 v249, v249, v251
    v_lshlrev_b32 v249, 7, v249
    s_movk_i32 s34, 3584
    v_mul_lo_u32 v250, v250, s34
    v_add_u32 v249, v249, v250
    s_lshr_b32 s34, s30, 2
    s_mul_i32 s3, s34, 1792
    s_mov_b32 s48, s16
    s_mov_b32 s49, s17
    s_mov_b32 s50, 1835008
    s_mov_b32 s51, 0x00020000
    buffer_load_dword v248, v249, s[48:51], s3 offen
L_pfd_6:
    v_and_b32 v10, 31, v0
    v_lshrrev_b32 v11, 5, v0
    v_and_b32 v12, 15, v0
    v_bfe_u32 v13, v0, 4, 1
    v_bfe_u32 v14, v10, 1, 3
    v_lshlrev_b32 v80, 7, v10
    s_lshr_b32 s3, s28, 1
    s_lshl_b32 s3, s3, 13
    s_add_u32 s3, s3, 32768
    v_add_u32 v80, s3, v80
    v_add_u32 v83, 0, v11
    v_xor_b32 v83, v83, v14
    v_lshl_add_u32 v6, v83, 4, v80
    v_add_u32 v83, 2, v11
    v_xor_b32 v83, v83, v14
    v_lshl_add_u32 v7, v83, 4, v80
    v_add_u32 v83, 4, v11
    v_xor_b32 v83, v83, v14
    v_lshl_add_u32 v81, v83, 4, v80
    v_add_u32 v83, 6, v11
    v_xor_b32 v83, v83, v14
    v_lshl_add_u32 v82, v83, 4, v80
    v_lshrrev_b32 v14, 2, v12
    v_lshl_add_u32 v80, v11, 3, v14
    v_lshlrev_b32 v80, 8, v80
    s_and_b32 s3, s28, 1
    s_lshl_b32 s3, s3, 1
    v_xor_b32 v14, s3, v14
    v_lshlrev_b32 v14, 2, v14
    v_lshl_add_u32 v14, v13, 1, v14
    v_bfe_u32 v83, v12, 1, 1
    v_add_u32 v14, v14, v83
    v_lshl_add_u32 v80, v14, 4, v80
    v_and_b32 v83, 1, v12
    v_lshl_add_u32 v8, v83, 3, v80
    v_xor_b32 v9, 64, v8
    s_setprio 0
    s_waitcnt vmcnt(12)
    s_barrier
    v_readfirstlane_b32 s32, v253
    s_nop 0
    s_add_u32 s32, s32, 1
    s_not_b32 s33, s32
    ds_read_b128 v[16:19], v6 offset:0
    ds_read_b128 v[20:23], v6 offset:4096
    ds_read_b64_tr_b16 v[32:33], v8 offset:0
    ds_read_b64_tr_b16 v[34:35], v8 offset:1024
    ds_read_b64_tr_b16 v[36:37], v9 offset:0
    ds_read_b64_tr_b16 v[38:39], v9 offset:1024
    ds_read_b128 v[24:27], v7 offset:0
    ds_read_b128 v[28:31], v7 offset:4096
    ds_read_b64_tr_b16 v[40:41], v8 offset:4096
    ds_read_b64_tr_b16 v[42:43], v8 offset:5120
    ds_read_b64_tr_b16 v[44:45], v9 offset:4096
    ds_read_b64_tr_b16 v[46:47], v9 offset:5120
    s_waitcnt lgkmcnt(0)
    s_waitcnt vmcnt(8)
    s_barrier
    v_mfma_f32_32x32x16_bf16 v[128:143], v[32:35], v[16:19], 0
    s_add_u32 m0, s62, 73728
    s_add_u32 s3, s60, 65792
    buffer_load_dwordx4 v3, s[36:39], s3 offen lds
    ds_read_b128 v[48:51], v81 offset:0
    v_mfma_f32_32x32x16_bf16 v[144:159], v[32:35], v[20:23], 0
    buffer_load_dwordx4 v4, s[36:39], s3 offen offset:1024 lds
    ds_read_b128 v[52:55], v81 offset:4096
    v_mfma_f32_32x32x16_bf16 v[160:175], v[36:39], v[16:19], 0
    s_add_u32 m0, s62, 0
    s_add_u32 s3, s61, 458752
    buffer_load_dwordx4 v1, s[40:43], s3 offen lds
    ds_read_b64_tr_b16 v[64:65], v8 offset:8192
    v_mfma_f32_32x32x16_bf16 v[176:191], v[36:39], v[20:23], 0
    buffer_load_dwordx4 v2, s[40:43], s3 offen offset:1024 lds
    ds_read_b64_tr_b16 v[66:67], v8 offset:9216
    v_mfma_f32_32x32x16_bf16 v[128:143], v[40:43], v[24:27], v[128:143]
    ds_read_b64_tr_b16 v[68:69], v9 offset:8192
    ds_read_b64_tr_b16 v[70:71], v9 offset:9216
    v_mfma_f32_32x32x16_bf16 v[144:159], v[40:43], v[28:31], v[144:159]
    ds_read_b128 v[56:59], v82 offset:0
    ds_read_b128 v[60:63], v82 offset:4096
    v_mfma_f32_32x32x16_bf16 v[160:175], v[44:47], v[24:27], v[160:175]
    ds_read_b64_tr_b16 v[72:73], v8 offset:12288
    ds_read_b64_tr_b16 v[74:75], v8 offset:13312
    v_mfma_f32_32x32x16_bf16 v[176:191], v[44:47], v[28:31], v[176:191]
    ds_read_b64_tr_b16 v[76:77], v9 offset:12288
    ds_read_b64_tr_b16 v[78:79], v9 offset:13312
    s_waitcnt lgkmcnt(0)
    s_waitcnt vmcnt(8)
    s_barrier
    v_mfma_f32_32x32x16_bf16 v[128:143], v[64:67], v[48:51], v[128:143]
    s_add_u32 m0, s62, 32768
    s_add_u32 s3, s60, 384
    buffer_load_dwordx4 v3, s[36:39], s3 offen lds
    ds_read_b128 v[16:19], v6 offset:16384
    v_mfma_f32_32x32x16_bf16 v[144:159], v[64:67], v[52:55], v[144:159]
    buffer_load_dwordx4 v4, s[36:39], s3 offen offset:1024 lds
    ds_read_b128 v[20:23], v6 offset:20480
    v_mfma_f32_32x32x16_bf16 v[160:175], v[68:71], v[48:51], v[160:175]
    s_add_u32 m0, s62, 8192
    s_add_u32 s3, s61, 573440
    buffer_load_dwordx4 v1, s[40:43], s3 offen lds
    ds_read_b64_tr_b16 v[32:33], v8 offset:16384
    v_mfma_f32_32x32x16_bf16 v[176:191], v[68:71], v[52:55], v[176:191]
    buffer_load_dwordx4 v2, s[40:43], s3 offen offset:1024 lds
    ds_read_b64_tr_b16 v[34:35], v8 offset:17408
    v_mfma_f32_32x32x16_bf16 v[128:143], v[72:75], v[56:59], v[128:143]
    ds_read_b64_tr_b16 v[36:37], v9 offset:16384
    ds_read_b64_tr_b16 v[38:39], v9 offset:17408
    v_mfma_f32_32x32x16_bf16 v[144:159], v[72:75], v[60:63], v[144:159]
    ds_read_b128 v[24:27], v7 offset:16384
    ds_read_b128 v[28:31], v7 offset:20480
    v_mfma_f32_32x32x16_bf16 v[160:175], v[76:79], v[56:59], v[160:175]
    ds_read_b64_tr_b16 v[40:41], v8 offset:20480
    ds_read_b64_tr_b16 v[42:43], v8 offset:21504
    v_mfma_f32_32x32x16_bf16 v[176:191], v[76:79], v[60:63], v[176:191]
    ds_read_b64_tr_b16 v[44:45], v9 offset:20480
    ds_read_b64_tr_b16 v[46:47], v9 offset:21504
    s_waitcnt lgkmcnt(0)
    s_waitcnt vmcnt(8)
    s_barrier
    v_mfma_f32_32x32x16_bf16 v[128:143], v[32:35], v[16:19], v[128:143]
    s_add_u32 m0, s62, 40960
    s_add_u32 s3, s60, 65920
    buffer_load_dwordx4 v3, s[36:39], s3 offen lds
    ds_read_b128 v[48:51], v81 offset:16384
    v_mfma_f32_32x32x16_bf16 v[144:159], v[32:35], v[20:23], v[144:159]
    buffer_load_dwordx4 v4, s[36:39], s3 offen offset:1024 lds
    ds_read_b128 v[52:55], v81 offset:20480
    v_mfma_f32_32x32x16_bf16 v[160:175], v[36:39], v[16:19], v[160:175]
    s_add_u32 m0, s62, 16384
    s_add_u32 s3, s61, 688128
    buffer_load_dwordx4 v1, s[40:43], s3 offen lds
    ds_read_b64_tr_b16 v[64:65], v8 offset:24576
    v_mfma_f32_32x32x16_bf16 v[176:191], v[36:39], v[20:23], v[176:191]
    buffer_load_dwordx4 v2, s[40:43], s3 offen offset:1024 lds
    ds_read_b64_tr_b16 v[66:67], v8 offset:25600
    v_mfma_f32_32x32x16_bf16 v[128:143], v[40:43], v[24:27], v[128:143]
    ds_read_b64_tr_b16 v[68:69], v9 offset:24576
    ds_read_b64_tr_b16 v[70:71], v9 offset:25600
    v_mfma_f32_32x32x16_bf16 v[144:159], v[40:43], v[28:31], v[144:159]
    ds_read_b128 v[56:59], v82 offset:16384
    ds_read_b128 v[60:63], v82 offset:20480
    v_mfma_f32_32x32x16_bf16 v[160:175], v[44:47], v[24:27], v[160:175]
    ds_read_b64_tr_b16 v[72:73], v8 offset:28672
    ds_read_b64_tr_b16 v[74:75], v8 offset:29696
    v_mfma_f32_32x32x16_bf16 v[176:191], v[44:47], v[28:31], v[176:191]
    ds_read_b64_tr_b16 v[76:77], v9 offset:28672
    ds_read_b64_tr_b16 v[78:79], v9 offset:29696
    s_waitcnt lgkmcnt(0)
    s_waitcnt vmcnt(8)
    s_barrier
    v_mfma_f32_32x32x16_bf16 v[128:143], v[64:67], v[48:51], v[128:143]
    s_add_u32 m0, s62, 49152
    s_add_u32 s3, s60, 512
    buffer_load_dwordx4 v3, s[36:39], s3 offen lds
    ds_read_b128 v[16:19], v6 offset:32768
    v_mfma_f32_32x32x16_bf16 v[144:159], v[64:67], v[52:55], v[144:159]
    buffer_load_dwordx4 v4, s[36:39], s3 offen offset:1024 lds
    ds_read_b128 v[20:23], v6 offset:36864
    v_mfma_f32_32x32x16_bf16 v[160:175], v[68:71], v[48:51], v[160:175]
    s_add_u32 m0, s62, 24576
    s_add_u32 s3, s61, 802816
    buffer_load_dwordx4 v1, s[40:43], s3 offen lds
    ds_read_b64_tr_b16 v[32:33], v8 offset:0
    v_mfma_f32_32x32x16_bf16 v[176:191], v[68:71], v[52:55], v[176:191]
    buffer_load_dwordx4 v2, s[40:43], s3 offen offset:1024 lds
    ds_read_b64_tr_b16 v[34:35], v8 offset:1024
    v_mfma_f32_32x32x16_bf16 v[128:143], v[72:75], v[56:59], v[128:143]
    ds_read_b64_tr_b16 v[36:37], v9 offset:0
    ds_read_b64_tr_b16 v[38:39], v9 offset:1024
    v_mfma_f32_32x32x16_bf16 v[144:159], v[72:75], v[60:63], v[144:159]
    ds_read_b128 v[24:27], v7 offset:32768
    ds_read_b128 v[28:31], v7 offset:36864
    v_mfma_f32_32x32x16_bf16 v[160:175], v[76:79], v[56:59], v[160:175]
    ds_read_b64_tr_b16 v[40:41], v8 offset:4096
    ds_read_b64_tr_b16 v[42:43], v8 offset:5120
    v_mfma_f32_32x32x16_bf16 v[176:191], v[76:79], v[60:63], v[176:191]
    ds_read_b64_tr_b16 v[44:45], v9 offset:4096
    ds_read_b64_tr_b16 v[46:47], v9 offset:5120
    s_waitcnt lgkmcnt(0)
    s_waitcnt vmcnt(8)
    s_barrier
    v_mfma_f32_32x32x16_bf16 v[128:143], v[32:35], v[16:19], v[128:143]
    s_add_u32 m0, s62, 57344
    s_add_u32 s3, s60, 66048
    buffer_load_dwordx4 v3, s[36:39], s3 offen lds
    ds_read_b128 v[48:51], v81 offset:32768
    v_mfma_f32_32x32x16_bf16 v[144:159], v[32:35], v[20:23], v[144:159]
    buffer_load_dwordx4 v4, s[36:39], s3 offen offset:1024 lds
    ds_read_b128 v[52:55], v81 offset:36864
    v_mfma_f32_32x32x16_bf16 v[160:175], v[36:39], v[16:19], v[160:175]
    s_add_u32 m0, s62, 0
    s_add_u32 s3, s61, 917504
    buffer_load_dwordx4 v1, s[40:43], s3 offen lds
    ds_read_b64_tr_b16 v[64:65], v8 offset:8192
    v_mfma_f32_32x32x16_bf16 v[176:191], v[36:39], v[20:23], v[176:191]
    buffer_load_dwordx4 v2, s[40:43], s3 offen offset:1024 lds
    ds_read_b64_tr_b16 v[66:67], v8 offset:9216
    v_mfma_f32_32x32x16_bf16 v[128:143], v[40:43], v[24:27], v[128:143]
    ds_read_b64_tr_b16 v[68:69], v9 offset:8192
    ds_read_b64_tr_b16 v[70:71], v9 offset:9216
    v_mfma_f32_32x32x16_bf16 v[144:159], v[40:43], v[28:31], v[144:159]
    ds_read_b128 v[56:59], v82 offset:32768
    ds_read_b128 v[60:63], v82 offset:36864
    v_mfma_f32_32x32x16_bf16 v[160:175], v[44:47], v[24:27], v[160:175]
    ds_read_b64_tr_b16 v[72:73], v8 offset:12288
    ds_read_b64_tr_b16 v[74:75], v8 offset:13312
    v_mfma_f32_32x32x16_bf16 v[176:191], v[44:47], v[28:31], v[176:191]
    ds_read_b64_tr_b16 v[76:77], v9 offset:12288
    ds_read_b64_tr_b16 v[78:79], v9 offset:13312
    s_waitcnt lgkmcnt(0)
    s_waitcnt vmcnt(8)
    s_barrier
    v_mfma_f32_32x32x16_bf16 v[128:143], v[64:67], v[48:51], v[128:143]
    s_add_u32 m0, s62, 65536
    s_add_u32 s3, s60, 640
    buffer_load_dwordx4 v3, s[36:39], s3 offen lds
    ds_read_b128 v[16:19], v6 offset:0
    v_mfma_f32_32x32x16_bf16 v[144:159], v[64:67], v[52:55], v[144:159]
    buffer_load_dwordx4 v4, s[36:39], s3 offen offset:1024 lds
    ds_read_b128 v[20:23], v6 offset:4096
    v_mfma_f32_32x32x16_bf16 v[160:175], v[68:71], v[48:51], v[160:175]
    s_add_u32 m0, s62, 8192
    s_add_u32 s3, s61, 1032192
    buffer_load_dwordx4 v1, s[40:43], s3 offen lds
    ds_read_b64_tr_b16 v[32:33], v8 offset:16384
    v_mfma_f32_32x32x16_bf16 v[176:191], v[68:71], v[52:55], v[176:191]
    buffer_load_dwordx4 v2, s[40:43], s3 offen offset:1024 lds
    ds_read_b64_tr_b16 v[34:35], v8 offset:17408
    v_mfma_f32_32x32x16_bf16 v[128:143], v[72:75], v[56:59], v[128:143]
    ds_read_b64_tr_b16 v[36:37], v9 offset:16384
    ds_read_b64_tr_b16 v[38:39], v9 offset:17408
    v_mfma_f32_32x32x16_bf16 v[144:159], v[72:75], v[60:63], v[144:159]
    ds_read_b128 v[24:27], v7 offset:0
    ds_read_b128 v[28:31], v7 offset:4096
    v_mfma_f32_32x32x16_bf16 v[160:175], v[76:79], v[56:59], v[160:175]
    ds_read_b64_tr_b16 v[40:41], v8 offset:20480
    ds_read_b64_tr_b16 v[42:43], v8 offset:21504
    v_mfma_f32_32x32x16_bf16 v[176:191], v[76:79], v[60:63], v[176:191]
    ds_read_b64_tr_b16 v[44:45], v9 offset:20480
    ds_read_b64_tr_b16 v[46:47], v9 offset:21504
    s_waitcnt lgkmcnt(0)
    s_waitcnt vmcnt(8)
    s_barrier
    v_mfma_f32_32x32x16_bf16 v[128:143], v[32:35], v[16:19], v[128:143]
    s_add_u32 m0, s62, 73728
    s_add_u32 s3, s60, 66176
    buffer_load_dwordx4 v3, s[36:39], s3 offen lds
    ds_read_b128 v[48:51], v81 offset:0
    v_mfma_f32_32x32x16_bf16 v[144:159], v[32:35], v[20:23], v[144:159]
    buffer_load_dwordx4 v4, s[36:39], s3 offen offset:1024 lds
    ds_read_b128 v[52:55], v81 offset:4096
    v_mfma_f32_32x32x16_bf16 v[160:175], v[36:39], v[16:19], v[160:175]
    s_add_u32 m0, s62, 16384
    s_add_u32 s3, s61, 1146880
    buffer_load_dwordx4 v1, s[40:43], s3 offen lds
    ds_read_b64_tr_b16 v[64:65], v8 offset:24576
    v_mfma_f32_32x32x16_bf16 v[176:191], v[36:39], v[20:23], v[176:191]
    buffer_load_dwordx4 v2, s[40:43], s3 offen offset:1024 lds
    ds_read_b64_tr_b16 v[66:67], v8 offset:25600
    v_mfma_f32_32x32x16_bf16 v[128:143], v[40:43], v[24:27], v[128:143]
    ds_read_b64_tr_b16 v[68:69], v9 offset:24576
    ds_read_b64_tr_b16 v[70:71], v9 offset:25600
    v_mfma_f32_32x32x16_bf16 v[144:159], v[40:43], v[28:31], v[144:159]
    ds_read_b128 v[56:59], v82 offset:0
    ds_read_b128 v[60:63], v82 offset:4096
    v_mfma_f32_32x32x16_bf16 v[160:175], v[44:47], v[24:27], v[160:175]
    ds_read_b64_tr_b16 v[72:73], v8 offset:28672
    ds_read_b64_tr_b16 v[74:75], v8 offset:29696
    v_mfma_f32_32x32x16_bf16 v[176:191], v[44:47], v[28:31], v[176:191]
    ds_read_b64_tr_b16 v[76:77], v9 offset:28672
    ds_read_b64_tr_b16 v[78:79], v9 offset:29696
    s_waitcnt lgkmcnt(0)
    s_waitcnt vmcnt(8)
    s_barrier
    v_mfma_f32_32x32x16_bf16 v[128:143], v[64:67], v[48:51], v[128:143]
    s_add_u32 m0, s62, 32768
    s_add_u32 s3, s60, 768
    buffer_load_dwordx4 v3, s[36:39], s3 offen lds
    ds_read_b128 v[16:19], v6 offset:16384
    v_mfma_f32_32x32x16_bf16 v[144:159], v[64:67], v[52:55], v[144:159]
    buffer_load_dwordx4 v4, s[36:39], s3 offen offset:1024 lds
    ds_read_b128 v[20:23], v6 offset:20480
    v_mfma_f32_32x32x16_bf16 v[160:175], v[68:71], v[48:51], v[160:175]
    s_add_u32 m0, s62, 24576
    s_add_u32 s3, s61, 1261568
    buffer_load_dwordx4 v1, s[40:43], s3 offen lds
    ds_read_b64_tr_b16 v[32:33], v8 offset:0
    v_mfma_f32_32x32x16_bf16 v[176:191], v[68:71], v[52:55], v[176:191]
    buffer_load_dwordx4 v2, s[40:43], s3 offen offset:1024 lds
    ds_read_b64_tr_b16 v[34:35], v8 offset:1024
    v_mfma_f32_32x32x16_bf16 v[128:143], v[72:75], v[56:59], v[128:143]
    ds_read_b64_tr_b16 v[36:37], v9 offset:0
    ds_read_b64_tr_b16 v[38:39], v9 offset:1024
    v_mfma_f32_32x32x16_bf16 v[144:159], v[72:75], v[60:63], v[144:159]
    ds_read_b128 v[24:27], v7 offset:16384
    ds_read_b128 v[28:31], v7 offset:20480
    v_mfma_f32_32x32x16_bf16 v[160:175], v[76:79], v[56:59], v[160:175]
    ds_read_b64_tr_b16 v[40:41], v8 offset:4096
    ds_read_b64_tr_b16 v[42:43], v8 offset:5120
    v_mfma_f32_32x32x16_bf16 v[176:191], v[76:79], v[60:63], v[176:191]
    ds_read_b64_tr_b16 v[44:45], v9 offset:4096
    ds_read_b64_tr_b16 v[46:47], v9 offset:5120
    s_waitcnt lgkmcnt(0)
    s_waitcnt vmcnt(8)
    s_barrier
    v_mfma_f32_32x32x16_bf16 v[128:143], v[32:35], v[16:19], v[128:143]
    s_add_u32 m0, s62, 40960
    s_add_u32 s3, s60, 66304
    buffer_load_dwordx4 v3, s[36:39], s3 offen lds
    ds_read_b128 v[48:51], v81 offset:16384
    v_mfma_f32_32x32x16_bf16 v[144:159], v[32:35], v[20:23], v[144:159]
    buffer_load_dwordx4 v4, s[36:39], s3 offen offset:1024 lds
    ds_read_b128 v[52:55], v81 offset:20480
    v_mfma_f32_32x32x16_bf16 v[160:175], v[36:39], v[16:19], v[160:175]
    s_add_u32 m0, s62, 0
    s_add_u32 s3, s61, 1376256
    buffer_load_dwordx4 v1, s[40:43], s3 offen lds
    ds_read_b64_tr_b16 v[64:65], v8 offset:8192
    v_mfma_f32_32x32x16_bf16 v[176:191], v[36:39], v[20:23], v[176:191]
    buffer_load_dwordx4 v2, s[40:43], s3 offen offset:1024 lds
    ds_read_b64_tr_b16 v[66:67], v8 offset:9216
    v_mfma_f32_32x32x16_bf16 v[128:143], v[40:43], v[24:27], v[128:143]
    ds_read_b64_tr_b16 v[68:69], v9 offset:8192
    ds_read_b64_tr_b16 v[70:71], v9 offset:9216
    v_mfma_f32_32x32x16_bf16 v[144:159], v[40:43], v[28:31], v[144:159]
    ds_read_b128 v[56:59], v82 offset:16384
    ds_read_b128 v[60:63], v82 offset:20480
    v_mfma_f32_32x32x16_bf16 v[160:175], v[44:47], v[24:27], v[160:175]
    ds_read_b64_tr_b16 v[72:73], v8 offset:12288
    ds_read_b64_tr_b16 v[74:75], v8 offset:13312
    v_mfma_f32_32x32x16_bf16 v[176:191], v[44:47], v[28:31], v[176:191]
    ds_read_b64_tr_b16 v[76:77], v9 offset:12288
    ds_read_b64_tr_b16 v[78:79], v9 offset:13312
    s_waitcnt lgkmcnt(0)
    s_waitcnt vmcnt(8)
    s_barrier
    v_mfma_f32_32x32x16_bf16 v[128:143], v[64:67], v[48:51], v[128:143]
    s_add_u32 m0, s62, 49152
    s_add_u32 s3, s60, 896
    buffer_load_dwordx4 v3, s[36:39], s3 offen lds
    ds_read_b128 v[16:19], v6 offset:32768
    v_mfma_f32_32x32x16_bf16 v[144:159], v[64:67], v[52:55], v[144:159]
    buffer_load_dwordx4 v4, s[36:39], s3 offen offset:1024 lds
    ds_read_b128 v[20:23], v6 offset:36864
    v_mfma_f32_32x32x16_bf16 v[160:175], v[68:71], v[48:51], v[160:175]
    s_add_u32 m0, s62, 8192
    s_add_u32 s3, s61, 1490944
    buffer_load_dwordx4 v1, s[40:43], s3 offen lds
    ds_read_b64_tr_b16 v[32:33], v8 offset:16384
    v_mfma_f32_32x32x16_bf16 v[176:191], v[68:71], v[52:55], v[176:191]
    buffer_load_dwordx4 v2, s[40:43], s3 offen offset:1024 lds
    ds_read_b64_tr_b16 v[34:35], v8 offset:17408
    v_mfma_f32_32x32x16_bf16 v[128:143], v[72:75], v[56:59], v[128:143]
    ds_read_b64_tr_b16 v[36:37], v9 offset:16384
    ds_read_b64_tr_b16 v[38:39], v9 offset:17408
    v_mfma_f32_32x32x16_bf16 v[144:159], v[72:75], v[60:63], v[144:159]
    ds_read_b128 v[24:27], v7 offset:32768
    ds_read_b128 v[28:31], v7 offset:36864
    v_mfma_f32_32x32x16_bf16 v[160:175], v[76:79], v[56:59], v[160:175]
    ds_read_b64_tr_b16 v[40:41], v8 offset:20480
    ds_read_b64_tr_b16 v[42:43], v8 offset:21504
    v_mfma_f32_32x32x16_bf16 v[176:191], v[76:79], v[60:63], v[176:191]
    ds_read_b64_tr_b16 v[44:45], v9 offset:20480
    ds_read_b64_tr_b16 v[46:47], v9 offset:21504
    s_waitcnt lgkmcnt(0)
    s_waitcnt vmcnt(8)
    s_barrier
    v_mfma_f32_32x32x16_bf16 v[128:143], v[32:35], v[16:19], v[128:143]
    s_add_u32 m0, s62, 57344
    s_add_u32 s3, s60, 66432
    buffer_load_dwordx4 v3, s[36:39], s3 offen lds
    ds_read_b128 v[48:51], v81 offset:32768
    v_mfma_f32_32x32x16_bf16 v[144:159], v[32:35], v[20:23], v[144:159]
    buffer_load_dwordx4 v4, s[36:39], s3 offen offset:1024 lds
    ds_read_b128 v[52:55], v81 offset:36864
    v_mfma_f32_32x32x16_bf16 v[160:175], v[36:39], v[16:19], v[160:175]
    s_add_u32 m0, s62, 16384
    s_add_u32 s3, s61, 1605632
    buffer_load_dwordx4 v1, s[40:43], s3 offen lds
    ds_read_b64_tr_b16 v[64:65], v8 offset:24576
    v_mfma_f32_32x32x16_bf16 v[176:191], v[36:39], v[20:23], v[176:191]
    buffer_load_dwordx4 v2, s[40:43], s3 offen offset:1024 lds
    ds_read_b64_tr_b16 v[66:67], v8 offset:25600
    v_mfma_f32_32x32x16_bf16 v[128:143], v[40:43], v[24:27], v[128:143]
    ds_read_b64_tr_b16 v[68:69], v9 offset:24576
    ds_read_b64_tr_b16 v[70:71], v9 offset:25600
    v_mfma_f32_32x32x16_bf16 v[144:159], v[40:43], v[28:31], v[144:159]
    ds_read_b128 v[56:59], v82 offset:32768
    ds_read_b128 v[60:63], v82 offset:36864
    v_mfma_f32_32x32x16_bf16 v[160:175], v[44:47], v[24:27], v[160:175]
    ds_read_b64_tr_b16 v[72:73], v8 offset:28672
    ds_read_b64_tr_b16 v[74:75], v8 offset:29696
    v_mfma_f32_32x32x16_bf16 v[176:191], v[44:47], v[28:31], v[176:191]
    ds_read_b64_tr_b16 v[76:77], v9 offset:28672
    ds_read_b64_tr_b16 v[78:79], v9 offset:29696
    s_waitcnt lgkmcnt(0)
    s_waitcnt vmcnt(8)
    s_barrier
    v_mfma_f32_32x32x16_bf16 v[128:143], v[64:67], v[48:51], v[128:143]
    s_add_u32 m0, s62, 24576
    s_add_u32 s3, s61, 1720320
    buffer_load_dwordx4 v1, s[40:43], s3 offen lds
    ds_read_b128 v[16:19], v6 offset:0
    v_mfma_f32_32x32x16_bf16 v[144:159], v[64:67], v[52:55], v[144:159]
    buffer_load_dwordx4 v2, s[40:43], s3 offen offset:1024 lds
    ds_read_b128 v[20:23], v6 offset:4096
    v_mfma_f32_32x32x16_bf16 v[160:175], v[68:71], v[48:51], v[160:175]
    ds_read_b64_tr_b16 v[32:33], v8 offset:0
    ds_read_b64_tr_b16 v[34:35], v8 offset:1024
    v_mfma_f32_32x32x16_bf16 v[176:191], v[68:71], v[52:55], v[176:191]
    ds_read_b64_tr_b16 v[36:37], v9 offset:0
    ds_read_b64_tr_b16 v[38:39], v9 offset:1024
    v_mfma_f32_32x32x16_bf16 v[128:143], v[72:75], v[56:59], v[128:143]
    ds_read_b128 v[24:27], v7 offset:0
    ds_read_b128 v[28:31], v7 offset:4096
    v_mfma_f32_32x32x16_bf16 v[144:159], v[72:75], v[60:63], v[144:159]
    ds_read_b64_tr_b16 v[40:41], v8 offset:4096
    ds_read_b64_tr_b16 v[42:43], v8 offset:5120
    v_mfma_f32_32x32x16_bf16 v[160:175], v[76:79], v[56:59], v[160:175]
    ds_read_b64_tr_b16 v[44:45], v9 offset:4096
    ds_read_b64_tr_b16 v[46:47], v9 offset:5120
    v_mfma_f32_32x32x16_bf16 v[176:191], v[76:79], v[60:63], v[176:191]
    s_waitcnt lgkmcnt(0)
    s_waitcnt vmcnt(6)
    s_barrier
    v_mfma_f32_32x32x16_bf16 v[128:143], v[32:35], v[16:19], v[128:143]
    ds_read_b128 v[48:51], v81 offset:0
    ds_read_b128 v[52:55], v81 offset:4096
    v_mfma_f32_32x32x16_bf16 v[144:159], v[32:35], v[20:23], v[144:159]
    ds_read_b64_tr_b16 v[64:65], v8 offset:8192
    ds_read_b64_tr_b16 v[66:67], v8 offset:9216
    v_mfma_f32_32x32x16_bf16 v[160:175], v[36:39], v[16:19], v[160:175]
    ds_read_b64_tr_b16 v[68:69], v9 offset:8192
    ds_read_b64_tr_b16 v[70:71], v9 offset:9216
    v_mfma_f32_32x32x16_bf16 v[176:191], v[36:39], v[20:23], v[176:191]
    ds_read_b128 v[56:59], v82 offset:0
    ds_read_b128 v[60:63], v82 offset:4096
    v_mfma_f32_32x32x16_bf16 v[128:143], v[40:43], v[24:27], v[128:143]
    ds_read_b64_tr_b16 v[72:73], v8 offset:12288
    ds_read_b64_tr_b16 v[74:75], v8 offset:13312
    v_mfma_f32_32x32x16_bf16 v[144:159], v[40:43], v[28:31], v[144:159]
    ds_read_b64_tr_b16 v[76:77], v9 offset:12288
    ds_read_b64_tr_b16 v[78:79], v9 offset:13312
    v_mfma_f32_32x32x16_bf16 v[160:175], v[44:47], v[24:27], v[160:175]
    v_mfma_f32_32x32x16_bf16 v[176:191], v[44:47], v[28:31], v[176:191]
    s_waitcnt lgkmcnt(0)
    s_waitcnt vmcnt(2)
    s_barrier
    v_mfma_f32_32x32x16_bf16 v[128:143], v[64:67], v[48:51], v[128:143]
    ds_read_b128 v[16:19], v6 offset:16384
    ds_read_b128 v[20:23], v6 offset:20480
    v_mfma_f32_32x32x16_bf16 v[144:159], v[64:67], v[52:55], v[144:159]
    ds_read_b64_tr_b16 v[32:33], v8 offset:16384
    ds_read_b64_tr_b16 v[34:35], v8 offset:17408
    v_mfma_f32_32x32x16_bf16 v[160:175], v[68:71], v[48:51], v[160:175]
    ds_read_b64_tr_b16 v[36:37], v9 offset:16384
    ds_read_b64_tr_b16 v[38:39], v9 offset:17408
    v_mfma_f32_32x32x16_bf16 v[176:191], v[68:71], v[52:55], v[176:191]
    ds_read_b128 v[24:27], v7 offset:16384
    ds_read_b128 v[28:31], v7 offset:20480
    v_mfma_f32_32x32x16_bf16 v[128:143], v[72:75], v[56:59], v[128:143]
    ds_read_b64_tr_b16 v[40:41], v8 offset:20480
    ds_read_b64_tr_b16 v[42:43], v8 offset:21504
    v_mfma_f32_32x32x16_bf16 v[144:159], v[72:75], v[60:63], v[144:159]
    ds_read_b64_tr_b16 v[44:45], v9 offset:20480
    ds_read_b64_tr_b16 v[46:47], v9 offset:21504
    v_mfma_f32_32x32x16_bf16 v[160:175], v[76:79], v[56:59], v[160:175]
    v_mfma_f32_32x32x16_bf16 v[176:191], v[76:79], v[60:63], v[176:191]
    s_waitcnt lgkmcnt(0)
    s_waitcnt vmcnt(0)
    s_barrier
    v_mfma_f32_32x32x16_bf16 v[128:143], v[32:35], v[16:19], v[128:143]
    ds_read_b128 v[48:51], v81 offset:16384
    ds_read_b128 v[52:55], v81 offset:20480
    v_mfma_f32_32x32x16_bf16 v[144:159], v[32:35], v[20:23], v[144:159]
    ds_read_b64_tr_b16 v[64:65], v8 offset:24576
    ds_read_b64_tr_b16 v[66:67], v8 offset:25600
    v_mfma_f32_32x32x16_bf16 v[160:175], v[36:39], v[16:19], v[160:175]
    ds_read_b64_tr_b16 v[68:69], v9 offset:24576
    ds_read_b64_tr_b16 v[70:71], v9 offset:25600
    v_mfma_f32_32x32x16_bf16 v[176:191], v[36:39], v[20:23], v[176:191]
    ds_read_b128 v[56:59], v82 offset:16384
    ds_read_b128 v[60:63], v82 offset:20480
    v_mfma_f32_32x32x16_bf16 v[128:143], v[40:43], v[24:27], v[128:143]
    ds_read_b64_tr_b16 v[72:73], v8 offset:28672
    ds_read_b64_tr_b16 v[74:75], v8 offset:29696
    v_mfma_f32_32x32x16_bf16 v[144:159], v[40:43], v[28:31], v[144:159]
    ds_read_b64_tr_b16 v[76:77], v9 offset:28672
    ds_read_b64_tr_b16 v[78:79], v9 offset:29696
    v_mfma_f32_32x32x16_bf16 v[160:175], v[44:47], v[24:27], v[160:175]
    v_mfma_f32_32x32x16_bf16 v[176:191], v[44:47], v[28:31], v[176:191]
    s_waitcnt lgkmcnt(0)
    s_barrier
    v_mfma_f32_32x32x16_bf16 v[128:143], v[64:67], v[48:51], v[128:143]
    v_mfma_f32_32x32x16_bf16 v[144:159], v[64:67], v[52:55], v[144:159]
    v_mfma_f32_32x32x16_bf16 v[160:175], v[68:71], v[48:51], v[160:175]
    v_mfma_f32_32x32x16_bf16 v[176:191], v[68:71], v[52:55], v[176:191]
    v_mfma_f32_32x32x16_bf16 v[128:143], v[72:75], v[56:59], v[128:143]
    v_mfma_f32_32x32x16_bf16 v[144:159], v[72:75], v[60:63], v[144:159]
    v_mfma_f32_32x32x16_bf16 v[160:175], v[76:79], v[56:59], v[160:175]
    v_mfma_f32_32x32x16_bf16 v[176:191], v[76:79], v[60:63], v[176:191]
    s_lshr_b32 s3, s2, 3
    s_and_b32 s3, s3, 31
    s_lshl_b32 s3, s3, 2
    s_add_u32 s68, s3, s28
    v_lshrrev_b32 v249, 2, v0
    v_lshlrev_b32 v249, 10, v249
    v_and_b32 v250, 3, v0
    v_lshl_add_u32 v249, v250, 7, v249
    s_lshr_b32 s34, s30, 2
    s_lshl_b32 s34, s34, 9
    s_cmp_ge_u32 s68, 112
    s_cbranch_scc1 L_pfwo_7
    s_lshl_b32 s3, s68, 14
    s_add_u32 s3, s3, s34
    s_mov_b32 s48, s18
    s_mov_b32 s49, s19
    s_mov_b32 s50, 1835008
    s_mov_b32 s51, 0x00020000
    buffer_load_dword v248, v249, s[48:51], s3 offen
    s_branch L_pfd_8
L_pfwo_7:
    s_sub_u32 s3, s68, 112
    s_lshl_b32 s3, s3, 15
    s_add_u32 s3, s3, s34
    s_mov_b32 s48, s12
    s_mov_b32 s49, s13
    s_mov_b32 s50, 524288
    s_mov_b32 s51, 0x00020000
    buffer_load_dword v248, v249, s[48:51], s3 offen
    s_add_u32 s3, s3, 16384
    buffer_load_dword v248, v249, s[48:51], s3 offen
L_pfd_8:
    v_lshlrev_b32 v9, 4, v0
    s_lshl_b32 s60, s76, 1
    s_lshr_b32 s3, s28, 1
    s_add_u32 s60, s60, s3
    s_mov_b32 s64, s60
    s_mul_i32 s60, s60, 224
    s_lshl_b32 s3, s77, 3
    s_add_u32 s60, s60, s3
    s_and_b32 s3, s28, 1
    s_lshl_b32 s3, s3, 2
    s_add_u32 s60, s60, s3
    s_lshl_b32 s60, s60, 10
    s_add_u32 s60, s60, 3145728
    s_mov_b32 s34, 0xbfb8aa3b
    s_mov_b32 s35, 0xbfb8aa3b
    s_setprio 2
    s_nop 4
    v_pk_mul_f32 v[16:17], v[128:129], s[34:35]
    v_pk_mul_f32 v[18:19], v[130:131], s[34:35]
    v_pk_mul_f32 v[20:21], v[132:133], s[34:35]
    v_pk_mul_f32 v[22:23], v[134:135], s[34:35]
    v_pk_mul_f32 v[24:25], v[136:137], s[34:35]
    v_pk_mul_f32 v[26:27], v[138:139], s[34:35]
    v_pk_mul_f32 v[28:29], v[140:141], s[34:35]
    v_pk_mul_f32 v[30:31], v[142:143], s[34:35]
    v_exp_f32 v16, v16
    v_exp_f32 v17, v17
    v_exp_f32 v18, v18
    v_exp_f32 v19, v19
    v_exp_f32 v20, v20
    v_exp_f32 v21, v21
    v_exp_f32 v22, v22
    v_exp_f32 v23, v23
    v_exp_f32 v24, v24
    v_exp_f32 v25, v25
    v_exp_f32 v26, v26
    v_exp_f32 v27, v27
    v_exp_f32 v28, v28
    v_exp_f32 v29, v29
    v_exp_f32 v30, v30
    v_exp_f32 v31, v31
    v_pk_add_f32 v[16:17], v[16:17], 1.0 op_sel_hi:[1,0]
    v_pk_add_f32 v[18:19], v[18:19], 1.0 op_sel_hi:[1,0]
    v_pk_add_f32 v[20:21], v[20:21], 1.0 op_sel_hi:[1,0]
    v_pk_add_f32 v[22:23], v[22:23], 1.0 op_sel_hi:[1,0]
    v_pk_add_f32 v[24:25], v[24:25], 1.0 op_sel_hi:[1,0]
    v_pk_add_f32 v[26:27], v[26:27], 1.0 op_sel_hi:[1,0]
    v_pk_add_f32 v[28:29], v[28:29], 1.0 op_sel_hi:[1,0]
    v_pk_add_f32 v[30:31], v[30:31], 1.0 op_sel_hi:[1,0]
    v_rcp_f32 v16, v16
    v_rcp_f32 v17, v17
    v_rcp_f32 v18, v18
    v_rcp_f32 v19, v19
    v_rcp_f32 v20, v20
    v_rcp_f32 v21, v21
    v_rcp_f32 v22, v22
    v_rcp_f32 v23, v23
    v_rcp_f32 v24, v24
    v_rcp_f32 v25, v25
    v_rcp_f32 v26, v26
    v_rcp_f32 v27, v27
    v_rcp_f32 v28, v28
    v_rcp_f32 v29, v29
    v_rcp_f32 v30, v30
    v_rcp_f32 v31, v31
    v_pk_mul_f32 v[128:129], v[128:129], v[16:17]
    v_pk_mul_f32 v[130:131], v[130:131], v[18:19]
    v_pk_mul_f32 v[132:133], v[132:133], v[20:21]
    v_pk_mul_f32 v[134:135], v[134:135], v[22:23]
    v_pk_mul_f32 v[136:137], v[136:137], v[24:25]
    v_pk_mul_f32 v[138:139], v[138:139], v[26:27]
    v_pk_mul_f32 v[140:141], v[140:141], v[28:29]
    v_pk_mul_f32 v[142:143], v[142:143], v[30:31]
    v_cvt_pk_bf16_f32 v32, v128, v129
    v_cvt_pk_bf16_f32 v33, v130, v131
    v_cvt_pk_bf16_f32 v34, v132, v133
    v_cvt_pk_bf16_f32 v35, v134, v135
    v_cvt_pk_bf16_f32 v36, v136, v137
    v_cvt_pk_bf16_f32 v37, v138, v139
    v_cvt_pk_bf16_f32 v38, v140, v141
    v_cvt_pk_bf16_f32 v39, v142, v143
    s_add_u32 s3, s60, 0
    buffer_store_dwordx4 v[32:35], v9, s[52:55], s3 offen sc1
    s_add_u32 s3, s60, 1024
    buffer_store_dwordx4 v[36:39], v9, s[52:55], s3 offen sc1
    s_nop 0
    v_pk_mul_f32 v[16:17], v[144:145], s[34:35]
    v_pk_mul_f32 v[18:19], v[146:147], s[34:35]
    v_pk_mul_f32 v[20:21], v[148:149], s[34:35]
    v_pk_mul_f32 v[22:23], v[150:151], s[34:35]
    v_pk_mul_f32 v[24:25], v[152:153], s[34:35]
    v_pk_mul_f32 v[26:27], v[154:155], s[34:35]
    v_pk_mul_f32 v[28:29], v[156:157], s[34:35]
    v_pk_mul_f32 v[30:31], v[158:159], s[34:35]
    v_exp_f32 v16, v16
    v_exp_f32 v17, v17
    v_exp_f32 v18, v18
    v_exp_f32 v19, v19
    v_exp_f32 v20, v20
    v_exp_f32 v21, v21
    v_exp_f32 v22, v22
    v_exp_f32 v23, v23
    v_exp_f32 v24, v24
    v_exp_f32 v25, v25
    v_exp_f32 v26, v26
    v_exp_f32 v27, v27
    v_exp_f32 v28, v28
    v_exp_f32 v29, v29
    v_exp_f32 v30, v30
    v_exp_f32 v31, v31
    v_pk_add_f32 v[16:17], v[16:17], 1.0 op_sel_hi:[1,0]
    v_pk_add_f32 v[18:19], v[18:19], 1.0 op_sel_hi:[1,0]
    v_pk_add_f32 v[20:21], v[20:21], 1.0 op_sel_hi:[1,0]
    v_pk_add_f32 v[22:23], v[22:23], 1.0 op_sel_hi:[1,0]
    v_pk_add_f32 v[24:25], v[24:25], 1.0 op_sel_hi:[1,0]
    v_pk_add_f32 v[26:27], v[26:27], 1.0 op_sel_hi:[1,0]
    v_pk_add_f32 v[28:29], v[28:29], 1.0 op_sel_hi:[1,0]
    v_pk_add_f32 v[30:31], v[30:31], 1.0 op_sel_hi:[1,0]
    v_rcp_f32 v16, v16
    v_rcp_f32 v17, v17
    v_rcp_f32 v18, v18
    v_rcp_f32 v19, v19
    v_rcp_f32 v20, v20
    v_rcp_f32 v21, v21
    v_rcp_f32 v22, v22
    v_rcp_f32 v23, v23
    v_rcp_f32 v24, v24
    v_rcp_f32 v25, v25
    v_rcp_f32 v26, v26
    v_rcp_f32 v27, v27
    v_rcp_f32 v28, v28
    v_rcp_f32 v29, v29
    v_rcp_f32 v30, v30
    v_rcp_f32 v31, v31
    v_pk_mul_f32 v[144:145], v[144:145], v[16:17]
    v_pk_mul_f32 v[146:147], v[146:147], v[18:19]
    v_pk_mul_f32 v[148:149], v[148:149], v[20:21]
    v_pk_mul_f32 v[150:151], v[150:151], v[22:23]
    v_pk_mul_f32 v[152:153], v[152:153], v[24:25]
    v_pk_mul_f32 v[154:155], v[154:155], v[26:27]
    v_pk_mul_f32 v[156:157], v[156:157], v[28:29]
    v_pk_mul_f32 v[158:159], v[158:159], v[30:31]
    v_cvt_pk_bf16_f32 v32, v144, v145
    v_cvt_pk_bf16_f32 v33, v146, v147
    v_cvt_pk_bf16_f32 v34, v148, v149
    v_cvt_pk_bf16_f32 v35, v150, v151
    v_cvt_pk_bf16_f32 v36, v152, v153
    v_cvt_pk_bf16_f32 v37, v154, v155
    v_cvt_pk_bf16_f32 v38, v156, v157
    v_cvt_pk_bf16_f32 v39, v158, v159
    s_add_u32 s3, s60, 114688
    buffer_store_dwordx4 v[32:35], v9, s[52:55], s3 offen sc1
    s_add_u32 s3, s60, 115712
    buffer_store_dwordx4 v[36:39], v9, s[52:55], s3 offen sc1
    s_nop 0
    v_pk_mul_f32 v[16:17], v[160:161], s[34:35]
    v_pk_mul_f32 v[18:19], v[162:163], s[34:35]
    v_pk_mul_f32 v[20:21], v[164:165], s[34:35]
    v_pk_mul_f32 v[22:23], v[166:167], s[34:35]
    v_pk_mul_f32 v[24:25], v[168:169], s[34:35]
    v_pk_mul_f32 v[26:27], v[170:171], s[34:35]
    v_pk_mul_f32 v[28:29], v[172:173], s[34:35]
    v_pk_mul_f32 v[30:31], v[174:175], s[34:35]
    v_exp_f32 v16, v16
    v_exp_f32 v17, v17
    v_exp_f32 v18, v18
    v_exp_f32 v19, v19
    v_exp_f32 v20, v20
    v_exp_f32 v21, v21
    v_exp_f32 v22, v22
    v_exp_f32 v23, v23
    v_exp_f32 v24, v24
    v_exp_f32 v25, v25
    v_exp_f32 v26, v26
    v_exp_f32 v27, v27
    v_exp_f32 v28, v28
    v_exp_f32 v29, v29
    v_exp_f32 v30, v30
    v_exp_f32 v31, v31
    v_pk_add_f32 v[16:17], v[16:17], 1.0 op_sel_hi:[1,0]
    v_pk_add_f32 v[18:19], v[18:19], 1.0 op_sel_hi:[1,0]
    v_pk_add_f32 v[20:21], v[20:21], 1.0 op_sel_hi:[1,0]
    v_pk_add_f32 v[22:23], v[22:23], 1.0 op_sel_hi:[1,0]
    v_pk_add_f32 v[24:25], v[24:25], 1.0 op_sel_hi:[1,0]
    v_pk_add_f32 v[26:27], v[26:27], 1.0 op_sel_hi:[1,0]
    v_pk_add_f32 v[28:29], v[28:29], 1.0 op_sel_hi:[1,0]
    v_pk_add_f32 v[30:31], v[30:31], 1.0 op_sel_hi:[1,0]
    v_rcp_f32 v16, v16
    v_rcp_f32 v17, v17
    v_rcp_f32 v18, v18
    v_rcp_f32 v19, v19
    v_rcp_f32 v20, v20
    v_rcp_f32 v21, v21
    v_rcp_f32 v22, v22
    v_rcp_f32 v23, v23
    v_rcp_f32 v24, v24
    v_rcp_f32 v25, v25
    v_rcp_f32 v26, v26
    v_rcp_f32 v27, v27
    v_rcp_f32 v28, v28
    v_rcp_f32 v29, v29
    v_rcp_f32 v30, v30
    v_rcp_f32 v31, v31
    v_pk_mul_f32 v[160:161], v[160:161], v[16:17]
    v_pk_mul_f32 v[162:163], v[162:163], v[18:19]
    v_pk_mul_f32 v[164:165], v[164:165], v[20:21]
    v_pk_mul_f32 v[166:167], v[166:167], v[22:23]
    v_pk_mul_f32 v[168:169], v[168:169], v[24:25]
    v_pk_mul_f32 v[170:171], v[170:171], v[26:27]
    v_pk_mul_f32 v[172:173], v[172:173], v[28:29]
    v_pk_mul_f32 v[174:175], v[174:175], v[30:31]
    v_cvt_pk_bf16_f32 v32, v160, v161
    v_cvt_pk_bf16_f32 v33, v162, v163
    v_cvt_pk_bf16_f32 v34, v164, v165
    v_cvt_pk_bf16_f32 v35, v166, v167
    v_cvt_pk_bf16_f32 v36, v168, v169
    v_cvt_pk_bf16_f32 v37, v170, v171
    v_cvt_pk_bf16_f32 v38, v172, v173
    v_cvt_pk_bf16_f32 v39, v174, v175
    s_add_u32 s3, s60, 2048
    buffer_store_dwordx4 v[32:35], v9, s[52:55], s3 offen sc1
    s_add_u32 s3, s60, 3072
    buffer_store_dwordx4 v[36:39], v9, s[52:55], s3 offen sc1
    s_nop 0
    v_pk_mul_f32 v[16:17], v[176:177], s[34:35]
    v_pk_mul_f32 v[18:19], v[178:179], s[34:35]
    v_pk_mul_f32 v[20:21], v[180:181], s[34:35]
    v_pk_mul_f32 v[22:23], v[182:183], s[34:35]
    v_pk_mul_f32 v[24:25], v[184:185], s[34:35]
    v_pk_mul_f32 v[26:27], v[186:187], s[34:35]
    v_pk_mul_f32 v[28:29], v[188:189], s[34:35]
    v_pk_mul_f32 v[30:31], v[190:191], s[34:35]
    v_exp_f32 v16, v16
    v_exp_f32 v17, v17
    v_exp_f32 v18, v18
    v_exp_f32 v19, v19
    v_exp_f32 v20, v20
    v_exp_f32 v21, v21
    v_exp_f32 v22, v22
    v_exp_f32 v23, v23
    v_exp_f32 v24, v24
    v_exp_f32 v25, v25
    v_exp_f32 v26, v26
    v_exp_f32 v27, v27
    v_exp_f32 v28, v28
    v_exp_f32 v29, v29
    v_exp_f32 v30, v30
    v_exp_f32 v31, v31
    v_pk_add_f32 v[16:17], v[16:17], 1.0 op_sel_hi:[1,0]
    v_pk_add_f32 v[18:19], v[18:19], 1.0 op_sel_hi:[1,0]
    v_pk_add_f32 v[20:21], v[20:21], 1.0 op_sel_hi:[1,0]
    v_pk_add_f32 v[22:23], v[22:23], 1.0 op_sel_hi:[1,0]
    v_pk_add_f32 v[24:25], v[24:25], 1.0 op_sel_hi:[1,0]
    v_pk_add_f32 v[26:27], v[26:27], 1.0 op_sel_hi:[1,0]
    v_pk_add_f32 v[28:29], v[28:29], 1.0 op_sel_hi:[1,0]
    v_pk_add_f32 v[30:31], v[30:31], 1.0 op_sel_hi:[1,0]
    v_rcp_f32 v16, v16
    v_rcp_f32 v17, v17
    v_rcp_f32 v18, v18
    v_rcp_f32 v19, v19
    v_rcp_f32 v20, v20
    v_rcp_f32 v21, v21
    v_rcp_f32 v22, v22
    v_rcp_f32 v23, v23
    v_rcp_f32 v24, v24
    v_rcp_f32 v25, v25
    v_rcp_f32 v26, v26
    v_rcp_f32 v27, v27
    v_rcp_f32 v28, v28
    v_rcp_f32 v29, v29
    v_rcp_f32 v30, v30
    v_rcp_f32 v31, v31
    v_pk_mul_f32 v[176:177], v[176:177], v[16:17]
    v_pk_mul_f32 v[178:179], v[178:179], v[18:19]
    v_pk_mul_f32 v[180:181], v[180:181], v[20:21]
    v_pk_mul_f32 v[182:183], v[182:183], v[22:23]
    v_pk_mul_f32 v[184:185], v[184:185], v[24:25]
    v_pk_mul_f32 v[186:187], v[186:187], v[26:27]
    v_pk_mul_f32 v[188:189], v[188:189], v[28:29]
    v_pk_mul_f32 v[190:191], v[190:191], v[30:31]
    v_cvt_pk_bf16_f32 v32, v176, v177
    v_cvt_pk_bf16_f32 v33, v178, v179
    v_cvt_pk_bf16_f32 v34, v180, v181
    v_cvt_pk_bf16_f32 v35, v182, v183
    v_cvt_pk_bf16_f32 v36, v184, v185
    v_cvt_pk_bf16_f32 v37, v186, v187
    v_cvt_pk_bf16_f32 v38, v188, v189
    v_cvt_pk_bf16_f32 v39, v190, v191
    s_add_u32 s3, s60, 116736
    buffer_store_dwordx4 v[32:35], v9, s[52:55], s3 offen sc1
    s_add_u32 s3, s60, 117760
    buffer_store_dwordx4 v[36:39], v9, s[52:55], s3 offen sc1
    s_nop 0
    s_lshl_b32 s3, s64, 12
    s_lshl_b32 s34, s77, 1
    s_and_b32 s35, s28, 1
    s_add_u32 s34, s34, s35
    s_lshl_b32 s34, s34, 7
    s_add_u32 s3, s3, s34
    s_add_u32 s62, s3, 2359296
    s_waitcnt vmcnt(0)
    v_mov_b32 v16, s32
    v_mov_b32 v17, s33
    s_mov_b64 exec, 1
    buffer_store_dwordx2 v[16:17], off, s[52:55], s62 sc1
    s_mov_b64 exec, -1
L_G_ffn2:
    s_mov_b32 s36, s18
    s_mov_b32 s37, s19
    s_mov_b32 s38, 1835008
    s_mov_b32 s39, 0x00020000
    s_mov_b32 s40, s12
    s_mov_b32 s41, s13
    s_mov_b32 s42, 524288
    s_mov_b32 s43, 0x00020000
    s_cmp_lg_u32 s28, 0
    s_cbranch_scc1 L_nostart_9
    v_mov_b32 v12, s32
    v_mov_b32 v13, s33
    v_mov_b32 v14, 0
    s_lshl_b32 s3, s2, 3
    s_add_u32 s3, s3, 16384
    s_mov_b64 exec, 1
    buffer_store_dwordx2 v[12:13], v14, s[52:55], s3 offen sc1
    s_mov_b64 exec, -1
L_nostart_9:
    v_lshrrev_b32 v10, 3, v0
    v_lshlrev_b32 v10, 10, v10
    v_and_b32 v11, 7, v0
    v_bfe_u32 v12, v0, 4, 1
    v_lshlrev_b32 v12, 2, v12
    v_xor_b32 v11, v11, v12
    v_lshl_add_u32 v1, v11, 4, v10
    v_lshlrev_b32 v2, 4, v0
    v_lshrrev_b32 v11, 5, v0
    v_and_b32 v12, 15, v0
    v_bfe_u32 v13, v0, 4, 1
    v_lshrrev_b32 v14, 2, v12
    v_lshl_add_u32 v14, v11, 2, v14
    v_lshlrev_b32 v14, 7, v14
    v_bfe_u32 v15, v12, 1, 1
    v_lshl_add_u32 v15, v13, 1, v15
    v_bfe_u32 v10, v12, 3, 1
    v_lshlrev_b32 v10, 2, v10
    v_xor_b32 v15, v15, v10
    v_lshl_add_u32 v14, v15, 4, v14
    v_and_b32 v15, 1, v12
    v_lshl_add_u32 v14, v15, 3, v14
    s_lshl_b32 s64, s28, 14
    v_add_u32 v6, s64, v14
    v_xor_b32 v7, 64, v6
    s_mul_i32 s60, s28, 458752
    s_lshl_b32 s3, s30, 7
    s_add_u32 s60, s60, s3
    s_mul_i32 s61, s29, 224
    s_mul_i32 s34, s28, 28
    s_add_u32 s61, s61, s34
    s_lshl_b32 s61, s61, 10
    s_add_u32 s61, s61, 3145728
    s_lshl_b32 s65, s28, 17
    s_add_u32 s65, s65, s3
    s_add_u32 m0, s64, 0
    s_add_u32 s3, s60, 8192
    buffer_load_dwordx4 v1, s[36:39], s60 offen  lds
    s_add_u32 m0, s64, 1024
    s_nop 0
    buffer_load_dwordx4 v1, s[36:39], s3 offen  lds
    s_add_u32 s60, s60, 16384
    s_add_u32 m0, s64, 2048
    s_add_u32 s3, s60, 8192
    buffer_load_dwordx4 v1, s[36:39], s60 offen  lds
    s_add_u32 m0, s64, 3072
    s_nop 0
    buffer_load_dwordx4 v1, s[36:39], s3 offen  lds
    s_add_u32 s60, s60, 16384
    s_add_u32 m0, s64, 4096
    s_add_u32 s3, s60, 8192
    buffer_load_dwordx4 v1, s[36:39], s60 offen  lds
    s_add_u32 m0, s64, 5120
    s_nop 0
    buffer_load_dwordx4 v1, s[36:39], s3 offen  lds
    s_add_u32 s60, s60, 16384
    s_add_u32 m0, s64, 6144
    s_add_u32 s3, s60, 8192
    buffer_load_dwordx4 v1, s[36:39], s60 offen  lds
    s_add_u32 m0, s64, 7168
    s_nop 0
    buffer_load_dwordx4 v1, s[36:39], s3 offen  lds
    s_add_u32 s60, s60, 16384
    v_and_b32 v10, 7, v0
    v_min_u32 v10, 6, v10
    v_lshlrev_b32 v10, 7, v10
    s_lshl_b32 s3, s29, 12
    s_mul_i32 s34, s28, 896
    s_add_u32 s3, s3, s34
    s_add_u32 s62, s3, 2359296
    s_mov_b32 s63, 0
L_H_poll:
    buffer_load_dwordx2 v[12:13], v10, s[52:55], s62 offen sc1
    s_waitcnt vmcnt(0)
    v_cmp_eq_u32 vcc, s32, v12
    v_cmp_eq_u32 s[34:35], s33, v13
    s_nop 1
    s_and_b64 vcc, vcc, s[34:35]
    s_cmp_eq_u64 vcc, -1
    s_cbranch_scc1 L_H_ok
    s_add_u32 s63, s63, 1
    s_cmp_lt_u32 s63, 200000
    s_cbranch_scc0 L_H_to
    s_sleep 1
    s_branch L_H_poll
L_H_to:
    v_mov_b32 v254, 3
    v_mov_b32 v255, 0
    s_mov_b32 s3, 11534272
    buffer_store_dword v254, v255, s[52:55], s3 offen sc1
L_H_ok:
    s_setprio 0
    s_add_u32 s3, s61, 114688
    buffer_load_dwordx4 v[16:19], v2, s[52:55], s61 offen sc1
    buffer_load_dwordx4 v[20:23], v2, s[52:55], s3 offen sc1
    s_add_u32 s61, s61, 1024
    s_add_u32 s3, s61, 114688
    buffer_load_dwordx4 v[24:27], v2, s[52:55], s61 offen sc1
    buffer_load_dwordx4 v[28:31], v2, s[52:55], s3 offen sc1
    s_add_u32 s61, s61, 1024
    s_add_u32 s3, s61, 114688
    buffer_load_dwordx4 v[32:35], v2, s[52:55], s61 offen sc1
    buffer_load_dwordx4 v[36:39], v2, s[52:55], s3 offen sc1
    s_add_u32 s61, s61, 1024
    s_add_u32 s3, s61, 114688
    buffer_load_dwordx4 v[40:43], v2, s[52:55], s61 offen sc1
    buffer_load_dwordx4 v[44:47], v2, s[52:55], s3 offen sc1
    s_add_u32 s61, s61, 1024
    ds_read_b64_tr_b16 v[72:73], v6 offset:0
    ds_read_b64_tr_b16 v[74:75], v6 offset:1024
    ds_read_b64_tr_b16 v[76:77], v7 offset:0
    ds_read_b64_tr_b16 v[78:79], v7 offset:1024
    s_waitcnt vmcnt(6)
    ds_read_b64_tr_b16 v[88:89], v6 offset:2048
    ds_read_b64_tr_b16 v[90:91], v6 offset:3072
    ds_read_b64_tr_b16 v[92:93], v7 offset:2048
    ds_read_b64_tr_b16 v[94:95], v7 offset:3072
    s_waitcnt lgkmcnt(4)
    v_mfma_f32_32x32x16_bf16 v[128:143], v[72:75], v[16:19], 0
    v_mfma_f32_32x32x16_bf16 v[144:159], v[72:75], v[20:23], 0
    v_mfma_f32_32x32x16_bf16 v[160:175], v[76:79], v[16:19], 0
    v_mfma_f32_32x32x16_bf16 v[176:191], v[76:79], v[20:23], 0
    s_add_u32 m0, s64, 0
    s_add_u32 s3, s60, 8192
    buffer_load_dwordx4 v1, s[36:39], s60 offen  lds
    s_add_u32 m0, s64, 1024
    s_nop 0
    buffer_load_dwordx4 v1, s[36:39], s3 offen  lds
    s_add_u32 s60, s60, 16384
    s_add_u32 s3, s61, 114688
    buffer_load_dwordx4 v[16:19], v2, s[52:55], s61 offen sc1
    buffer_load_dwordx4 v[20:23], v2, s[52:55], s3 offen sc1
    s_add_u32 s61, s61, 1024
    s_waitcnt vmcnt(8)
    ds_read_b64_tr_b16 v[72:73], v6 offset:4096
    ds_read_b64_tr_b16 v[74:75], v6 offset:5120
    ds_read_b64_tr_b16 v[76:77], v7 offset:4096
    ds_read_b64_tr_b16 v[78:79], v7 offset:5120
    s_waitcnt lgkmcnt(4)
    v_mfma_f32_32x32x16_bf16 v[128:143], v[88:91], v[24:27], v[128:143]
    v_mfma_f32_32x32x16_bf16 v[144:159], v[88:91], v[28:31], v[144:159]
    v_mfma_f32_32x32x16_bf16 v[160:175], v[92:95], v[24:27], v[160:175]
    v_mfma_f32_32x32x16_bf16 v[176:191], v[92:95], v[28:31], v[176:191]
    s_add_u32 m0, s64, 2048
    s_add_u32 s3, s60, 8192
    buffer_load_dwordx4 v1, s[36:39], s60 offen  lds
    s_add_u32 m0, s64, 3072
    s_nop 0
    buffer_load_dwordx4 v1, s[36:39], s3 offen  lds
    s_add_u32 s60, s60, 16384
    s_add_u32 s3, s61, 114688
    buffer_load_dwordx4 v[24:27], v2, s[52:55], s61 offen sc1
    buffer_load_dwordx4 v[28:31], v2, s[52:55], s3 offen sc1
    s_add_u32 s61, s61, 1024
    s_waitcnt vmcnt(10)
    ds_read_b64_tr_b16 v[88:89], v6 offset:6144
    ds_read_b64_tr_b16 v[90:91], v6 offset:7168
    ds_read_b64_tr_b16 v[92:93], v7 offset:6144
    ds_read_b64_tr_b16 v[94:95], v7 offset:7168
    s_waitcnt lgkmcnt(4)
    v_mfma_f32_32x32x16_bf16 v[128:143], v[72:75], v[32:35], v[128:143]
    v_mfma_f32_32x32x16_bf16 v[144:159], v[72:75], v[36:39], v[144:159]
    v_mfma_f32_32x32x16_bf16 v[160:175], v[76:79], v[32:35], v[160:175]
    v_mfma_f32_32x32x16_bf16 v[176:191], v[76:79], v[36:39], v[176:191]
    s_add_u32 m0, s64, 4096
    s_add_u32 s3, s60, 8192
    buffer_load_dwordx4 v1, s[36:39], s60 offen  lds
    s_add_u32 m0, s64, 5120
    s_nop 0
    buffer_load_dwordx4 v1, s[36:39], s3 offen  lds
    s_add_u32 s60, s60, 16384
    s_add_u32 s3, s61, 114688
    buffer_load_dwordx4 v[32:35], v2, s[52:55], s61 offen sc1
    buffer_load_dwordx4 v[36:39], v2, s[52:55], s3 offen sc1
    s_add_u32 s61, s61, 1024
    s_waitcnt vmcnt(10)
    ds_read_b64_tr_b16 v[72:73], v6 offset:0
    ds_read_b64_tr_b16 v[74:75], v6 offset:1024
    ds_read_b64_tr_b16 v[76:77], v7 offset:0
    ds_read_b64_tr_b16 v[78:79], v7 offset:1024
    s_waitcnt lgkmcnt(4)
    v_mfma_f32_32x32x16_bf16 v[128:143], v[88:91], v[40:43], v[128:143]
    v_mfma_f32_32x32x16_bf16 v[144:159], v[88:91], v[44:47], v[144:159]
    v_mfma_f32_32x32x16_bf16 v[160:175], v[92:95], v[40:43], v[160:175]
    v_mfma_f32_32x32x16_bf16 v[176:191], v[92:95], v[44:47], v[176:191]
    s_add_u32 m0, s64, 6144
    s_add_u32 s3, s60, 8192
    buffer_load_dwordx4 v1, s[36:39], s60 offen  lds
    s_add_u32 m0, s64, 7168
    s_nop 0
    buffer_load_dwordx4 v1, s[36:39], s3 offen  lds
    s_add_u32 s60, s60, 16384
    s_add_u32 s3, s61, 114688
    buffer_load_dwordx4 v[40:43], v2, s[52:55], s61 offen sc1
    buffer_load_dwordx4 v[44:47], v2, s[52:55], s3 offen sc1
    s_add_u32 s61, s61, 1024
    s_waitcnt vmcnt(10)
    ds_read_b64_tr_b16 v[88:89], v6 offset:2048
    ds_read_b64_tr_b16 v[90:91], v6 offset:3072
    ds_read_b64_tr_b16 v[92:93], v7 offset:2048
    ds_read_b64_tr_b16 v[94:95], v7 offset:3072
    s_waitcnt lgkmcnt(4)
    v_mfma_f32_32x32x16_bf16 v[128:143], v[72:75], v[16:19], v[128:143]
    v_mfma_f32_32x32x16_bf16 v[144:159], v[72:75], v[20:23], v[144:159]
    v_mfma_f32_32x32x16_bf16 v[160:175], v[76:79], v[16:19], v[160:175]
    v_mfma_f32_32x32x16_bf16 v[176:191], v[76:79], v[20:23], v[176:191]
    s_add_u32 m0, s64, 0
    s_add_u32 s3, s60, 8192
    buffer_load_dwordx4 v1, s[36:39], s60 offen  lds
    s_add_u32 m0, s64, 1024
    s_nop 0
    buffer_load_dwordx4 v1, s[36:39], s3 offen  lds
    s_add_u32 s60, s60, 16384
    s_add_u32 s3, s61, 114688
    buffer_load_dwordx4 v[16:19], v2, s[52:55], s61 offen sc1
    buffer_load_dwordx4 v[20:23], v2, s[52:55], s3 offen sc1
    s_add_u32 s61, s61, 1024
    s_waitcnt vmcnt(10)
    ds_read_b64_tr_b16 v[72:73], v6 offset:4096
    ds_read_b64_tr_b16 v[74:75], v6 offset:5120
    ds_read_b64_tr_b16 v[76:77], v7 offset:4096
    ds_read_b64_tr_b16 v[78:79], v7 offset:5120
    s_waitcnt lgkmcnt(4)
    v_mfma_f32_32x32x16_bf16 v[128:143], v[88:91], v[24:27], v[128:143]
    v_mfma_f32_32x32x16_bf16 v[144:159], v[88:91], v[28:31], v[144:159]
    v_mfma_f32_32x32x16_bf16 v[160:175], v[92:95], v[24:27], v[160:175]
    v_mfma_f32_32x32x16_bf16 v[176:191], v[92:95], v[28:31], v[176:191]
    s_add_u32 m0, s64, 2048
    s_add_u32 s3, s60, 8192
    buffer_load_dwordx4 v1, s[36:39], s60 offen  lds
    s_add_u32 m0, s64, 3072
    s_nop 0
    buffer_load_dwordx4 v1, s[36:39], s3 offen  lds
    s_add_u32 s60, s60, 16384
    s_add_u32 s3, s61, 114688
    buffer_load_dwordx4 v[24:27], v2, s[52:55], s61 offen sc1
    buffer_load_dwordx4 v[28:31], v2, s[52:55], s3 offen sc1
    s_add_u32 s61, s61, 1024
    s_waitcnt vmcnt(10)
    ds_read_b64_tr_b16 v[88:89], v6 offset:6144
    ds_read_b64_tr_b16 v[90:91], v6 offset:7168
    ds_read_b64_tr_b16 v[92:93], v7 offset:6144
    ds_read_b64_tr_b16 v[94:95], v7 offset:7168
    s_waitcnt lgkmcnt(4)
    v_mfma_f32_32x32x16_bf16 v[128:143], v[72:75], v[32:35], v[128:143]
    v_mfma_f32_32x32x16_bf16 v[144:159], v[72:75], v[36:39], v[144:159]
    v_mfma_f32_32x32x16_bf16 v[160:175], v[76:79], v[32:35], v[160:175]
    v_mfma_f32_32x32x16_bf16 v[176:191], v[76:79], v[36:39], v[176:191]
    s_add_u32 m0, s64, 4096
    s_add_u32 s3, s60, 8192
    buffer_load_dwordx4 v1, s[36:39], s60 offen  lds
    s_add_u32 m0, s64, 5120
    s_nop 0
    buffer_load_dwordx4 v1, s[36:39], s3 offen  lds
    s_add_u32 s60, s60, 16384
    s_add_u32 s3, s61, 114688
    buffer_load_dwordx4 v[32:35], v2, s[52:55], s61 offen sc1
    buffer_load_dwordx4 v[36:39], v2, s[52:55], s3 offen sc1
    s_add_u32 s61, s61, 1024
    s_waitcnt vmcnt(10)
    ds_read_b64_tr_b16 v[72:73], v6 offset:0
    ds_read_b64_tr_b16 v[74:75], v6 offset:1024
    ds_read_b64_tr_b16 v[76:77], v7 offset:0
    ds_read_b64_tr_b16 v[78:79], v7 offset:1024
    s_waitcnt lgkmcnt(4)
    v_mfma_f32_32x32x16_bf16 v[128:143], v[88:91], v[40:43], v[128:143]
    v_mfma_f32_32x32x16_bf16 v[144:159], v[88:91], v[44:47], v[144:159]
    v_mfma_f32_32x32x16_bf16 v[160:175], v[92:95], v[40:43], v[160:175]
    v_mfma_f32_32x32x16_bf16 v[176:191], v[92:95], v[44:47], v[176:191]
    s_add_u32 m0, s64, 6144
    s_add_u32 s3, s60, 8192
    buffer_load_dwordx4 v1, s[36:39], s60 offen  lds
    s_add_u32 m0, s64, 7168
    s_nop 0
    buffer_load_dwordx4 v1, s[36:39], s3 offen  lds
    s_add_u32 s60, s60, 16384
    s_add_u32 s3, s61, 114688
    buffer_load_dwordx4 v[40:43], v2, s[52:55], s61 offen sc1
    buffer_load_dwordx4 v[44:47], v2, s[52:55], s3 offen sc1
    s_add_u32 s61, s61, 1024
    s_waitcnt vmcnt(10)
    ds_read_b64_tr_b16 v[88:89], v6 offset:2048
    ds_read_b64_tr_b16 v[90:91], v6 offset:3072
    ds_read_b64_tr_b16 v[92:93], v7 offset:2048
    ds_read_b64_tr_b16 v[94:95], v7 offset:3072
    s_waitcnt lgkmcnt(4)
    v_mfma_f32_32x32x16_bf16 v[128:143], v[72:75], v[16:19], v[128:143]
    v_mfma_f32_32x32x16_bf16 v[144:159], v[72:75], v[20:23], v[144:159]
    v_mfma_f32_32x32x16_bf16 v[160:175], v[76:79], v[16:19], v[160:175]
    v_mfma_f32_32x32x16_bf16 v[176:191], v[76:79], v[20:23], v[176:191]
    s_add_u32 m0, s64, 0
    s_add_u32 s3, s60, 8192
    buffer_load_dwordx4 v1, s[36:39], s60 offen  lds
    s_add_u32 m0, s64, 1024
    s_nop 0
    buffer_load_dwordx4 v1, s[36:39], s3 offen  lds
    s_add_u32 s60, s60, 16384
    s_add_u32 s3, s61, 114688
    buffer_load_dwordx4 v[16:19], v2, s[52:55], s61 offen sc1
    buffer_load_dwordx4 v[20:23], v2, s[52:55], s3 offen sc1
    s_add_u32 s61, s61, 1024
    s_waitcnt vmcnt(10)
    ds_read_b64_tr_b16 v[72:73], v6 offset:4096
    ds_read_b64_tr_b16 v[74:75], v6 offset:5120
    ds_read_b64_tr_b16 v[76:77], v7 offset:4096
    ds_read_b64_tr_b16 v[78:79], v7 offset:5120
    s_waitcnt lgkmcnt(4)
    v_mfma_f32_32x32x16_bf16 v[128:143], v[88:91], v[24:27], v[128:143]
    v_mfma_f32_32x32x16_bf16 v[144:159], v[88:91], v[28:31], v[144:159]
    v_mfma_f32_32x32x16_bf16 v[160:175], v[92:95], v[24:27], v[160:175]
    v_mfma_f32_32x32x16_bf16 v[176:191], v[92:95], v[28:31], v[176:191]
    s_add_u32 m0, s64, 2048
    s_add_u32 s3, s60, 8192
    buffer_load_dwordx4 v1, s[36:39], s60 offen  lds
    s_add_u32 m0, s64, 3072
    s_nop 0
    buffer_load_dwordx4 v1, s[36:39], s3 offen  lds
    s_add_u32 s60, s60, 16384
    s_add_u32 s3, s61, 114688
    buffer_load_dwordx4 v[24:27], v2, s[52:55], s61 offen sc1
    buffer_load_dwordx4 v[28:31], v2, s[52:55], s3 offen sc1
    s_add_u32 s61, s61, 1024
    s_waitcnt vmcnt(10)
    ds_read_b64_tr_b16 v[88:89], v6 offset:6144
    ds_read_b64_tr_b16 v[90:91], v6 offset:7168
    ds_read_b64_tr_b16 v[92:93], v7 offset:6144
    ds_read_b64_tr_b16 v[94:95], v7 offset:7168
    s_waitcnt lgkmcnt(4)
    v_mfma_f32_32x32x16_bf16 v[128:143], v[72:75], v[32:35], v[128:143]
    v_mfma_f32_32x32x16_bf16 v[144:159], v[72:75], v[36:39], v[144:159]
    v_mfma_f32_32x32x16_bf16 v[160:175], v[76:79], v[32:35], v[160:175]
    v_mfma_f32_32x32x16_bf16 v[176:191], v[76:79], v[36:39], v[176:191]
    s_add_u32 m0, s64, 4096
    s_add_u32 s3, s60, 8192
    buffer_load_dwordx4 v1, s[36:39], s60 offen  lds
    s_add_u32 m0, s64, 5120
    s_nop 0
    buffer_load_dwordx4 v1, s[36:39], s3 offen  lds
    s_add_u32 s60, s60, 16384
    s_add_u32 s3, s61, 114688
    buffer_load_dwordx4 v[32:35], v2, s[52:55], s61 offen sc1
    buffer_load_dwordx4 v[36:39], v2, s[52:55], s3 offen sc1
    s_add_u32 s61, s61, 1024
    s_waitcnt vmcnt(10)
    ds_read_b64_tr_b16 v[72:73], v6 offset:0
    ds_read_b64_tr_b16 v[74:75], v6 offset:1024
    ds_read_b64_tr_b16 v[76:77], v7 offset:0
    ds_read_b64_tr_b16 v[78:79], v7 offset:1024
    s_waitcnt lgkmcnt(4)
    v_mfma_f32_32x32x16_bf16 v[128:143], v[88:91], v[40:43], v[128:143]
    v_mfma_f32_32x32x16_bf16 v[144:159], v[88:91], v[44:47], v[144:159]
    v_mfma_f32_32x32x16_bf16 v[160:175], v[92:95], v[40:43], v[160:175]
    v_mfma_f32_32x32x16_bf16 v[176:191], v[92:95], v[44:47], v[176:191]
    s_add_u32 m0, s64, 6144
    s_add_u32 s3, s60, 8192
    buffer_load_dwordx4 v1, s[36:39], s60 offen  lds
    s_add_u32 m0, s64, 7168
    s_nop 0
    buffer_load_dwordx4 v1, s[36:39], s3 offen  lds
    s_add_u32 s60, s60, 16384
    s_add_u32 s3, s61, 114688
    buffer_load_dwordx4 v[40:43], v2, s[52:55], s61 offen sc1
    buffer_load_dwordx4 v[44:47], v2, s[52:55], s3 offen sc1
    s_add_u32 s61, s61, 1024
    s_waitcnt vmcnt(10)
    ds_read_b64_tr_b16 v[88:89], v6 offset:2048
    ds_read_b64_tr_b16 v[90:91], v6 offset:3072
    ds_read_b64_tr_b16 v[92:93], v7 offset:2048
    ds_read_b64_tr_b16 v[94:95], v7 offset:3072
    s_waitcnt lgkmcnt(4)
    v_mfma_f32_32x32x16_bf16 v[128:143], v[72:75], v[16:19], v[128:143]
    v_mfma_f32_32x32x16_bf16 v[144:159], v[72:75], v[20:23], v[144:159]
    v_mfma_f32_32x32x16_bf16 v[160:175], v[76:79], v[16:19], v[160:175]
    v_mfma_f32_32x32x16_bf16 v[176:191], v[76:79], v[20:23], v[176:191]
    s_add_u32 m0, s64, 0
    s_add_u32 s3, s60, 8192
    buffer_load_dwordx4 v1, s[36:39], s60 offen  lds
    s_add_u32 m0, s64, 1024
    s_nop 0
    buffer_load_dwordx4 v1, s[36:39], s3 offen  lds
    s_add_u32 s60, s60, 16384
    s_add_u32 s3, s61, 114688
    buffer_load_dwordx4 v[16:19], v2, s[52:55], s61 offen sc1
    buffer_load_dwordx4 v[20:23], v2, s[52:55], s3 offen sc1
    s_add_u32 s61, s61, 1024
    s_waitcnt vmcnt(10)
    ds_read_b64_tr_b16 v[72:73], v6 offset:4096
    ds_read_b64_tr_b16 v[74:75], v6 offset:5120
    ds_read_b64_tr_b16 v[76:77], v7 offset:4096
    ds_read_b64_tr_b16 v[78:79], v7 offset:5120
    s_waitcnt lgkmcnt(4)
    v_mfma_f32_32x32x16_bf16 v[128:143], v[88:91], v[24:27], v[128:143]
    v_mfma_f32_32x32x16_bf16 v[144:159], v[88:91], v[28:31], v[144:159]
    v_mfma_f32_32x32x16_bf16 v[160:175], v[92:95], v[24:27], v[160:175]
    v_mfma_f32_32x32x16_bf16 v[176:191], v[92:95], v[28:31], v[176:191]
    s_add_u32 m0, s64, 2048
    s_add_u32 s3, s60, 8192
    buffer_load_dwordx4 v1, s[36:39], s60 offen  lds
    s_add_u32 m0, s64, 3072
    s_nop 0
    buffer_load_dwordx4 v1, s[36:39], s3 offen  lds
    s_add_u32 s60, s60, 16384
    s_add_u32 s3, s61, 114688
    buffer_load_dwordx4 v[24:27], v2, s[52:55], s61 offen sc1
    buffer_load_dwordx4 v[28:31], v2, s[52:55], s3 offen sc1
    s_add_u32 s61, s61, 1024
    s_waitcnt vmcnt(10)
    ds_read_b64_tr_b16 v[88:89], v6 offset:6144
    ds_read_b64_tr_b16 v[90:91], v6 offset:7168
    ds_read_b64_tr_b16 v[92:93], v7 offset:6144
    ds_read_b64_tr_b16 v[94:95], v7 offset:7168
    s_waitcnt lgkmcnt(4)
    v_mfma_f32_32x32x16_bf16 v[128:143], v[72:75], v[32:35], v[128:143]
    v_mfma_f32_32x32x16_bf16 v[144:159], v[72:75], v[36:39], v[144:159]
    v_mfma_f32_32x32x16_bf16 v[160:175], v[76:79], v[32:35], v[160:175]
    v_mfma_f32_32x32x16_bf16 v[176:191], v[76:79], v[36:39], v[176:191]
    s_add_u32 m0, s64, 4096
    s_add_u32 s3, s60, 8192
    buffer_load_dwordx4 v1, s[36:39], s60 offen  lds
    s_add_u32 m0, s64, 5120
    s_nop 0
    buffer_load_dwordx4 v1, s[36:39], s3 offen  lds
    s_add_u32 s60, s60, 16384
    s_add_u32 s3, s61, 114688
    buffer_load_dwordx4 v[32:35], v2, s[52:55], s61 offen sc1
    buffer_load_dwordx4 v[36:39], v2, s[52:55], s3 offen sc1
    s_add_u32 s61, s61, 1024
    s_waitcnt vmcnt(10)
    ds_read_b64_tr_b16 v[72:73], v6 offset:0
    ds_read_b64_tr_b16 v[74:75], v6 offset:1024
    ds_read_b64_tr_b16 v[76:77], v7 offset:0
    ds_read_b64_tr_b16 v[78:79], v7 offset:1024
    s_waitcnt lgkmcnt(4)
    v_mfma_f32_32x32x16_bf16 v[128:143], v[88:91], v[40:43], v[128:143]
    v_mfma_f32_32x32x16_bf16 v[144:159], v[88:91], v[44:47], v[144:159]
    v_mfma_f32_32x32x16_bf16 v[160:175], v[92:95], v[40:43], v[160:175]
    v_mfma_f32_32x32x16_bf16 v[176:191], v[92:95], v[44:47], v[176:191]
    s_add_u32 m0, s64, 6144
    s_add_u32 s3, s60, 8192
    buffer_load_dwordx4 v1, s[36:39], s60 offen  lds
    s_add_u32 m0, s64, 7168
    s_nop 0
    buffer_load_dwordx4 v1, s[36:39], s3 offen  lds
    s_add_u32 s60, s60, 16384
    s_add_u32 s3, s61, 114688
    buffer_load_dwordx4 v[40:43], v2, s[52:55], s61 offen sc1
    buffer_load_dwordx4 v[44:47], v2, s[52:55], s3 offen sc1
    s_add_u32 s61, s61, 1024
    s_waitcnt vmcnt(10)
    ds_read_b64_tr_b16 v[88:89], v6 offset:2048
    ds_read_b64_tr_b16 v[90:91], v6 offset:3072
    ds_read_b64_tr_b16 v[92:93], v7 offset:2048
    ds_read_b64_tr_b16 v[94:95], v7 offset:3072
    s_waitcnt lgkmcnt(4)
    v_mfma_f32_32x32x16_bf16 v[128:143], v[72:75], v[16:19], v[128:143]
    v_mfma_f32_32x32x16_bf16 v[144:159], v[72:75], v[20:23], v[144:159]
    v_mfma_f32_32x32x16_bf16 v[160:175], v[76:79], v[16:19], v[160:175]
    v_mfma_f32_32x32x16_bf16 v[176:191], v[76:79], v[20:23], v[176:191]
    s_add_u32 m0, s64, 0
    s_add_u32 s3, s60, 8192
    buffer_load_dwordx4 v1, s[36:39], s60 offen  lds
    s_add_u32 m0, s64, 1024
    s_nop 0
    buffer_load_dwordx4 v1, s[36:39], s3 offen  lds
    s_add_u32 s60, s60, 16384
    s_add_u32 s3, s61, 114688
    buffer_load_dwordx4 v[16:19], v2, s[52:55], s61 offen sc1
    buffer_load_dwordx4 v[20:23], v2, s[52:55], s3 offen sc1
    s_add_u32 s61, s61, 1024
    s_waitcnt vmcnt(10)
    ds_read_b64_tr_b16 v[72:73], v6 offset:4096
    ds_read_b64_tr_b16 v[74:75], v6 offset:5120
    ds_read_b64_tr_b16 v[76:77], v7 offset:4096
    ds_read_b64_tr_b16 v[78:79], v7 offset:5120
    s_waitcnt lgkmcnt(4)
    v_mfma_f32_32x32x16_bf16 v[128:143], v[88:91], v[24:27], v[128:143]
    v_mfma_f32_32x32x16_bf16 v[144:159], v[88:91], v[28:31], v[144:159]
    v_mfma_f32_32x32x16_bf16 v[160:175], v[92:95], v[24:27], v[160:175]
    v_mfma_f32_32x32x16_bf16 v[176:191], v[92:95], v[28:31], v[176:191]
    s_add_u32 m0, s64, 2048
    s_add_u32 s3, s60, 8192
    buffer_load_dwordx4 v1, s[36:39], s60 offen  lds
    s_add_u32 m0, s64, 3072
    s_nop 0
    buffer_load_dwordx4 v1, s[36:39], s3 offen  lds
    s_add_u32 s60, s60, 16384
    s_add_u32 s3, s61, 114688
    buffer_load_dwordx4 v[24:27], v2, s[52:55], s61 offen sc1
    buffer_load_dwordx4 v[28:31], v2, s[52:55], s3 offen sc1
    s_add_u32 s61, s61, 1024
    s_waitcnt vmcnt(10)
    ds_read_b64_tr_b16 v[88:89], v6 offset:6144
    ds_read_b64_tr_b16 v[90:91], v6 offset:7168
    ds_read_b64_tr_b16 v[92:93], v7 offset:6144
    ds_read_b64_tr_b16 v[94:95], v7 offset:7168
    s_waitcnt lgkmcnt(4)
    v_mfma_f32_32x32x16_bf16 v[128:143], v[72:75], v[32:35], v[128:143]
    v_mfma_f32_32x32x16_bf16 v[144:159], v[72:75], v[36:39], v[144:159]
    v_mfma_f32_32x32x16_bf16 v[160:175], v[76:79], v[32:35], v[160:175]
    v_mfma_f32_32x32x16_bf16 v[176:191], v[76:79], v[36:39], v[176:191]
    s_add_u32 m0, s64, 4096
    s_add_u32 s3, s60, 8192
    buffer_load_dwordx4 v1, s[36:39], s60 offen  lds
    s_add_u32 m0, s64, 5120
    s_nop 0
    buffer_load_dwordx4 v1, s[36:39], s3 offen  lds
    s_add_u32 s60, s60, 16384
    s_add_u32 s3, s61, 114688
    buffer_load_dwordx4 v[32:35], v2, s[52:55], s61 offen sc1
    buffer_load_dwordx4 v[36:39], v2, s[52:55], s3 offen sc1
    s_add_u32 s61, s61, 1024
    s_waitcnt vmcnt(10)
    ds_read_b64_tr_b16 v[72:73], v6 offset:0
    ds_read_b64_tr_b16 v[74:75], v6 offset:1024
    ds_read_b64_tr_b16 v[76:77], v7 offset:0
    ds_read_b64_tr_b16 v[78:79], v7 offset:1024
    s_waitcnt lgkmcnt(4)
    v_mfma_f32_32x32x16_bf16 v[128:143], v[88:91], v[40:43], v[128:143]
    v_mfma_f32_32x32x16_bf16 v[144:159], v[88:91], v[44:47], v[144:159]
    v_mfma_f32_32x32x16_bf16 v[160:175], v[92:95], v[40:43], v[160:175]
    v_mfma_f32_32x32x16_bf16 v[176:191], v[92:95], v[44:47], v[176:191]
    s_add_u32 m0, s64, 6144
    s_add_u32 s3, s60, 8192
    buffer_load_dwordx4 v1, s[36:39], s60 offen  lds
    s_add_u32 m0, s64, 7168
    s_nop 0
    buffer_load_dwordx4 v1, s[36:39], s3 offen  lds
    s_add_u32 s60, s60, 16384
    s_add_u32 s3, s61, 114688
    buffer_load_dwordx4 v[40:43], v2, s[52:55], s61 offen sc1
    buffer_load_dwordx4 v[44:47], v2, s[52:55], s3 offen sc1
    s_add_u32 s61, s61, 1024
    s_waitcnt vmcnt(10)
    ds_read_b64_tr_b16 v[88:89], v6 offset:2048
    ds_read_b64_tr_b16 v[90:91], v6 offset:3072
    ds_read_b64_tr_b16 v[92:93], v7 offset:2048
    ds_read_b64_tr_b16 v[94:95], v7 offset:3072
    s_waitcnt lgkmcnt(4)
    v_mfma_f32_32x32x16_bf16 v[128:143], v[72:75], v[16:19], v[128:143]
    v_mfma_f32_32x32x16_bf16 v[144:159], v[72:75], v[20:23], v[144:159]
    v_mfma_f32_32x32x16_bf16 v[160:175], v[76:79], v[16:19], v[160:175]
    v_mfma_f32_32x32x16_bf16 v[176:191], v[76:79], v[20:23], v[176:191]
    s_add_u32 m0, s64, 0
    s_add_u32 s3, s60, 8192
    buffer_load_dwordx4 v1, s[36:39], s60 offen  lds
    s_add_u32 m0, s64, 1024
    s_nop 0
    buffer_load_dwordx4 v1, s[36:39], s3 offen  lds
    s_add_u32 s60, s60, 16384
    s_add_u32 s3, s61, 114688
    buffer_load_dwordx4 v[16:19], v2, s[52:55], s61 offen sc1
    buffer_load_dwordx4 v[20:23], v2, s[52:55], s3 offen sc1
    s_add_u32 s61, s61, 1024
    s_waitcnt vmcnt(10)
    ds_read_b64_tr_b16 v[72:73], v6 offset:4096
    ds_read_b64_tr_b16 v[74:75], v6 offset:5120
    ds_read_b64_tr_b16 v[76:77], v7 offset:4096
    ds_read_b64_tr_b16 v[78:79], v7 offset:5120
    s_waitcnt lgkmcnt(4)
    v_mfma_f32_32x32x16_bf16 v[128:143], v[88:91], v[24:27], v[128:143]
    v_mfma_f32_32x32x16_bf16 v[144:159], v[88:91], v[28:31], v[144:159]
    v_mfma_f32_32x32x16_bf16 v[160:175], v[92:95], v[24:27], v[160:175]
    v_mfma_f32_32x32x16_bf16 v[176:191], v[92:95], v[28:31], v[176:191]
    s_add_u32 m0, s64, 2048
    s_add_u32 s3, s60, 8192
    buffer_load_dwordx4 v1, s[36:39], s60 offen  lds
    s_add_u32 m0, s64, 3072
    s_nop 0
    buffer_load_dwordx4 v1, s[36:39], s3 offen  lds
    s_add_u32 s60, s60, 16384
    s_add_u32 s3, s61, 114688
    buffer_load_dwordx4 v[24:27], v2, s[52:55], s61 offen sc1
    buffer_load_dwordx4 v[28:31], v2, s[52:55], s3 offen sc1
    s_add_u32 s61, s61, 1024
    s_waitcnt vmcnt(10)
    ds_read_b64_tr_b16 v[88:89], v6 offset:6144
    ds_read_b64_tr_b16 v[90:91], v6 offset:7168
    ds_read_b64_tr_b16 v[92:93], v7 offset:6144
    ds_read_b64_tr_b16 v[94:95], v7 offset:7168
    s_waitcnt lgkmcnt(4)
    v_mfma_f32_32x32x16_bf16 v[128:143], v[72:75], v[32:35], v[128:143]
    v_mfma_f32_32x32x16_bf16 v[144:159], v[72:75], v[36:39], v[144:159]
    v_mfma_f32_32x32x16_bf16 v[160:175], v[76:79], v[32:35], v[160:175]
    v_mfma_f32_32x32x16_bf16 v[176:191], v[76:79], v[36:39], v[176:191]
    s_add_u32 m0, s64, 4096
    s_add_u32 s3, s60, 8192
    buffer_load_dwordx4 v1, s[36:39], s60 offen  lds
    s_add_u32 m0, s64, 5120
    s_nop 0
    buffer_load_dwordx4 v1, s[36:39], s3 offen  lds
    s_add_u32 s60, s60, 16384
    s_add_u32 s3, s61, 114688
    buffer_load_dwordx4 v[32:35], v2, s[52:55], s61 offen sc1
    buffer_load_dwordx4 v[36:39], v2, s[52:55], s3 offen sc1
    s_add_u32 s61, s61, 1024
    s_waitcnt vmcnt(10)
    ds_read_b64_tr_b16 v[72:73], v6 offset:0
    ds_read_b64_tr_b16 v[74:75], v6 offset:1024
    ds_read_b64_tr_b16 v[76:77], v7 offset:0
    ds_read_b64_tr_b16 v[78:79], v7 offset:1024
    s_waitcnt lgkmcnt(4)
    v_mfma_f32_32x32x16_bf16 v[128:143], v[88:91], v[40:43], v[128:143]
    v_mfma_f32_32x32x16_bf16 v[144:159], v[88:91], v[44:47], v[144:159]
    v_mfma_f32_32x32x16_bf16 v[160:175], v[92:95], v[40:43], v[160:175]
    v_mfma_f32_32x32x16_bf16 v[176:191], v[92:95], v[44:47], v[176:191]
    s_add_u32 m0, s64, 6144
    s_add_u32 s3, s60, 8192
    buffer_load_dwordx4 v1, s[36:39], s60 offen  lds
    s_add_u32 m0, s64, 7168
    s_nop 0
    buffer_load_dwordx4 v1, s[36:39], s3 offen  lds
    s_add_u32 s60, s60, 16384
    s_add_u32 s3, s61, 114688
    buffer_load_dwordx4 v[40:43], v2, s[52:55], s61 offen sc1
    buffer_load_dwordx4 v[44:47], v2, s[52:55], s3 offen sc1
    s_add_u32 s61, s61, 1024
    s_waitcnt vmcnt(10)
    ds_read_b64_tr_b16 v[88:89], v6 offset:2048
    ds_read_b64_tr_b16 v[90:91], v6 offset:3072
    ds_read_b64_tr_b16 v[92:93], v7 offset:2048
    ds_read_b64_tr_b16 v[94:95], v7 offset:3072
    s_waitcnt lgkmcnt(4)
    v_mfma_f32_32x32x16_bf16 v[128:143], v[72:75], v[16:19], v[128:143]
    v_mfma_f32_32x32x16_bf16 v[144:159], v[72:75], v[20:23], v[144:159]
    v_mfma_f32_32x32x16_bf16 v[160:175], v[76:79], v[16:19], v[160:175]
    v_mfma_f32_32x32x16_bf16 v[176:191], v[76:79], v[20:23], v[176:191]
    s_waitcnt vmcnt(6)
    ds_read_b64_tr_b16 v[72:73], v6 offset:4096
    ds_read_b64_tr_b16 v[74:75], v6 offset:5120
    ds_read_b64_tr_b16 v[76:77], v7 offset:4096
    ds_read_b64_tr_b16 v[78:79], v7 offset:5120
    s_waitcnt lgkmcnt(4)
    v_mfma_f32_32x32x16_bf16 v[128:143], v[88:91], v[24:27], v[128:143]
    v_mfma_f32_32x32x16_bf16 v[144:159], v[88:91], v[28:31], v[144:159]
    v_mfma_f32_32x32x16_bf16 v[160:175], v[92:95], v[24:27], v[160:175]
    v_mfma_f32_32x32x16_bf16 v[176:191], v[92:95], v[28:31], v[176:191]
    s_waitcnt vmcnt(2)
    ds_read_b64_tr_b16 v[88:89], v6 offset:6144
    ds_read_b64_tr_b16 v[90:91], v6 offset:7168
    ds_read_b64_tr_b16 v[92:93], v7 offset:6144
    ds_read_b64_tr_b16 v[94:95], v7 offset:7168
    s_waitcnt lgkmcnt(4)
    v_mfma_f32_32x32x16_bf16 v[128:143], v[72:75], v[32:35], v[128:143]
    v_mfma_f32_32x32x16_bf16 v[144:159], v[72:75], v[36:39], v[144:159]
    v_mfma_f32_32x32x16_bf16 v[160:175], v[76:79], v[32:35], v[160:175]
    v_mfma_f32_32x32x16_bf16 v[176:191], v[76:79], v[36:39], v[176:191]
    s_waitcnt vmcnt(0)
    s_waitcnt lgkmcnt(0)
    v_mfma_f32_32x32x16_bf16 v[128:143], v[88:91], v[40:43], v[128:143]
    v_mfma_f32_32x32x16_bf16 v[144:159], v[88:91], v[44:47], v[144:159]
    v_mfma_f32_32x32x16_bf16 v[160:175], v[92:95], v[40:43], v[160:175]
    v_mfma_f32_32x32x16_bf16 v[176:191], v[92:95], v[44:47], v[176:191]
    s_cmp_lg_u32 s2, 511
    s_cbranch_scc1 L_EP_done
    s_cmp_lg_u32 s28, 3
    s_cbranch_scc1 L_EP_done
    v_lshlrev_b32 v10, 4, v0
    s_mov_b32 s63, 0
L_EP_poll:
    s_mov_b32 s3, 16384
    buffer_load_dwordx4 v[16:19], v10, s[52:55], s3 offen sc1
    s_mov_b32 s3, 17408
    buffer_load_dwordx4 v[20:23], v10, s[52:55], s3 offen sc1
    s_mov_b32 s3, 18432
    buffer_load_dwordx4 v[24:27], v10, s[52:55], s3 offen sc1
    s_mov_b32 s3, 19456
    buffer_load_dwordx4 v[28:31], v10, s[52:55], s3 offen sc1
    s_waitcnt vmcnt(0)
    s_mov_b64 s[70:71], -1
    v_cmp_eq_u32 vcc, s32, v16
    v_cmp_eq_u32 s[34:35], s33, v17
    s_nop 1
    s_and_b64 s[70:71], s[70:71], vcc
    s_and_b64 s[70:71], s[70:71], s[34:35]
    v_cmp_eq_u32 vcc, s32, v18
    v_cmp_eq_u32 s[34:35], s33, v19
    s_nop 1
    s_and_b64 s[70:71], s[70:71], vcc
    s_and_b64 s[70:71], s[70:71], s[34:35]
    v_cmp_eq_u32 vcc, s32, v20
    v_cmp_eq_u32 s[34:35], s33, v21
    s_nop 1
    s_and_b64 s[70:71], s[70:71], vcc
    s_and_b64 s[70:71], s[70:71], s[34:35]
    v_cmp_eq_u32 vcc, s32, v22
    v_cmp_eq_u32 s[34:35], s33, v23
    s_nop 1
    s_and_b64 s[70:71], s[70:71], vcc
    s_and_b64 s[70:71], s[70:71], s[34:35]
    v_cmp_eq_u32 vcc, s32, v24
    v_cmp_eq_u32 s[34:35], s33, v25
    s_nop 1
    s_and_b64 s[70:71], s[70:71], vcc
    s_and_b64 s[70:71], s[70:71], s[34:35]
    v_cmp_eq_u32 vcc, s32, v26
    v_cmp_eq_u32 s[34:35], s33, v27
    s_nop 1
    s_and_b64 s[70:71], s[70:71], vcc
    s_and_b64 s[70:71], s[70:71], s[34:35]
    v_cmp_eq_u32 vcc, s32, v28
    v_cmp_eq_u32 s[34:35], s33, v29
    s_nop 1
    s_and_b64 s[70:71], s[70:71], vcc
    s_and_b64 s[70:71], s[70:71], s[34:35]
    v_cmp_eq_u32 vcc, s32, v30
    v_cmp_eq_u32 s[34:35], s33, v31
    s_nop 1
    s_and_b64 s[70:71], s[70:71], vcc
    s_and_b64 s[70:71], s[70:71], s[34:35]
    s_cmp_eq_u64 s[70:71], -1
    s_cbranch_scc1 L_EP_ok
    s_add_u32 s63, s63, 1
    s_cmp_lt_u32 s63, 200000
    s_cbranch_scc0 L_EP_done
    s_sleep 8
    s_branch L_EP_poll
L_EP_ok:
    v_mov_b32 v16, s32
    v_mov_b32 v17, 0
    s_mov_b32 s3, 0
    s_mov_b64 exec, 1
    buffer_store_dword v16, v17, s[52:55], s3 offen sc1
    s_mov_b64 exec, -1
L_EP_done:
    s_lshl_b32 s3, s28, 14
    v_lshl_add_u32 v10, v0, 4, s3
    s_lshl_b32 s3, s28, 12
    v_lshl_add_u32 v11, v0, 4, s3
    s_nop 7
    ds_write_b128 v10, v[128:131] offset:0
    ds_write_b128 v10, v[132:135] offset:1024
    ds_write_b128 v10, v[136:139] offset:2048
    ds_write_b128 v10, v[140:143] offset:3072
    ds_write_b128 v10, v[144:147] offset:4096
    ds_write_b128 v10, v[148:151] offset:5120
    ds_write_b128 v10, v[152:155] offset:6144
    ds_write_b128 v10, v[156:159] offset:7168
    ds_write_b128 v10, v[160:163] offset:8192
    ds_write_b128 v10, v[164:167] offset:9216
    ds_write_b128 v10, v[168:171] offset:10240
    ds_write_b128 v10, v[172:175] offset:11264
    ds_write_b128 v10, v[176:179] offset:12288
    ds_write_b128 v10, v[180:183] offset:13312
    ds_write_b128 v10, v[184:187] offset:14336
    ds_write_b128 v10, v[188:191] offset:15360
    s_waitcnt lgkmcnt(0)
    s_barrier
    ds_read_b128 v[16:19], v11 offset:0
    ds_read_b128 v[20:23], v11 offset:1024
    ds_read_b128 v[24:27], v11 offset:2048
    ds_read_b128 v[28:31], v11 offset:3072
    ds_read_b128 v[32:35], v11 offset:16384
    ds_read_b128 v[36:39], v11 offset:17408
    ds_read_b128 v[40:43], v11 offset:18432
    ds_read_b128 v[44:47], v11 offset:19456
    ds_read_b128 v[48:51], v11 offset:32768
    ds_read_b128 v[52:55], v11 offset:33792
    ds_read_b128 v[56:59], v11 offset:34816
    ds_read_b128 v[60:63], v11 offset:35840
    ds_read_b128 v[64:67], v11 offset:49152
    ds_read_b128 v[68:71], v11 offset:50176
    ds_read_b128 v[72:75], v11 offset:51200
    ds_read_b128 v[76:79], v11 offset:52224
    s_waitcnt lgkmcnt(0)
    s_barrier
    v_and_b32 v10, 1, v0
    v_lshlrev_b32 v10, 3, v10
    s_lshl_b32 s62, s29, 4
    s_add_u32 s62, s62, 12288
    s_mov_b32 s63, 0
L_GT_poll:
    buffer_load_dwordx2 v[8:9], v10, s[52:55], s62 offen sc1
    s_waitcnt vmcnt(0)
    v_cmp_eq_u32 vcc, s32, v8
    v_cmp_eq_u32 s[34:35], s33, v9
    s_nop 1
    s_and_b64 vcc, vcc, s[34:35]
    s_cmp_eq_u64 vcc, -1
    s_cbranch_scc1 L_GT_ok
    s_add_u32 s63, s63, 1
    s_cmp_lt_u32 s63, 200000
    s_cbranch_scc0 L_GT_to
    s_sleep 1
    s_branch L_GT_poll
L_GT_to:
    v_mov_b32 v254, 6
    v_mov_b32 v255, 0
    s_mov_b32 s3, 11534272
    buffer_store_dword v254, v255, s[52:55], s3 offen sc1
L_GT_ok:
    v_and_b32 v10, 31, v0
    v_lshlrev_b32 v10, 2, v10
    s_lshl_b32 s3, s29, 8
    s_and_b32 s34, s28, 1
    s_lshl_b32 s34, s34, 7
    s_add_u32 s3, s3, s34
    s_add_u32 s3, s3, 24576
    buffer_load_dword v4, v10, s[52:55], s3 offen sc1
    s_add_u32 m0, s64, 0
    s_add_u32 s3, s65, 8192
    buffer_load_dwordx4 v1, s[40:43], s65 offen  lds
    s_add_u32 m0, s64, 1024
    s_nop 0
    buffer_load_dwordx4 v1, s[40:43], s3 offen  lds
    s_add_u32 s65, s65, 16384
    s_add_u32 m0, s64, 2048
    s_add_u32 s3, s65, 8192
    buffer_load_dwordx4 v1, s[40:43], s65 offen  lds
    s_add_u32 m0, s64, 3072
    s_nop 0
    buffer_load_dwordx4 v1, s[40:43], s3 offen  lds
    s_add_u32 s65, s65, 16384
    s_add_u32 m0, s64, 4096
    s_add_u32 s3, s65, 8192
    buffer_load_dwordx4 v1, s[40:43], s65 offen  lds
    s_add_u32 m0, s64, 5120
    s_nop 0
    buffer_load_dwordx4 v1, s[40:43], s3 offen  lds
    s_add_u32 s65, s65, 16384
    s_add_u32 m0, s64, 6144
    s_add_u32 s3, s65, 8192
    buffer_load_dwordx4 v1, s[40:43], s65 offen  lds
    s_add_u32 m0, s64, 7168
    s_nop 0
    buffer_load_dwordx4 v1, s[40:43], s3 offen  lds
    s_add_u32 s65, s65, 16384
    s_add_u32 m0, s64, 8192
    s_add_u32 s3, s65, 8192
    buffer_load_dwordx4 v1, s[40:43], s65 offen  lds
    s_add_u32 m0, s64, 9216
    s_nop 0
    buffer_load_dwordx4 v1, s[40:43], s3 offen  lds
    s_add_u32 s65, s65, 16384
    s_add_u32 m0, s64, 10240
    s_add_u32 s3, s65, 8192
    buffer_load_dwordx4 v1, s[40:43], s65 offen  lds
    s_add_u32 m0, s64, 11264
    s_nop 0
    buffer_load_dwordx4 v1, s[40:43], s3 offen  lds
    s_add_u32 s65, s65, 16384
    s_add_u32 m0, s64, 12288
    s_add_u32 s3, s65, 8192
    buffer_load_dwordx4 v1, s[40:43], s65 offen  lds
    s_add_u32 m0, s64, 13312
    s_nop 0
    buffer_load_dwordx4 v1, s[40:43], s3 offen  lds
    s_add_u32 s65, s65, 16384
    s_add_u32 m0, s64, 14336
    s_add_u32 s3, s65, 8192
    buffer_load_dwordx4 v1, s[40:43], s65 offen  lds
    s_add_u32 m0, s64, 15360
    s_nop 0
    buffer_load_dwordx4 v1, s[40:43], s3 offen  lds
    s_add_u32 s65, s65, 16384
    v_add_f32 v16, v16, v32
    v_add_f32 v48, v48, v64
    v_add_f32 v17, v17, v33
    v_add_f32 v49, v49, v65
    v_add_f32 v18, v18, v34
    v_add_f32 v50, v50, v66
    v_add_f32 v19, v19, v35
    v_add_f32 v51, v51, v67
    v_add_f32 v20, v20, v36
    v_add_f32 v52, v52, v68
    v_add_f32 v21, v21, v37
    v_add_f32 v53, v53, v69
    v_add_f32 v22, v22, v38
    v_add_f32 v54, v54, v70
    v_add_f32 v23, v23, v39
    v_add_f32 v55, v55, v71
    v_add_f32 v24, v24, v40
    v_add_f32 v56, v56, v72
    v_add_f32 v25, v25, v41
    v_add_f32 v57, v57, v73
    v_add_f32 v26, v26, v42
    v_add_f32 v58, v58, v74
    v_add_f32 v27, v27, v43
    v_add_f32 v59, v59, v75
    v_add_f32 v28, v28, v44
    v_add_f32 v60, v60, v76
    v_add_f32 v29, v29, v45
    v_add_f32 v61, v61, v77
    v_add_f32 v30, v30, v46
    v_add_f32 v62, v62, v78
    v_add_f32 v31, v31, v47
    v_add_f32 v63, v63, v79
    v_add_f32 v208, v16, v48
    v_add_f32 v209, v17, v49
    v_add_f32 v210, v18, v50
    v_add_f32 v211, v19, v51
    v_add_f32 v212, v20, v52
    v_add_f32 v213, v21, v53
    v_add_f32 v214, v22, v54
    v_add_f32 v215, v23, v55
    v_add_f32 v216, v24, v56
    v_add_f32 v217, v25, v57
    v_add_f32 v218, v26, v58
    v_add_f32 v219, v27, v59
    v_add_f32 v220, v28, v60
    v_add_f32 v221, v29, v61
    v_add_f32 v222, v30, v62
    v_add_f32 v223, v31, v63
    v_subrev_u32 v13, s64, v6
    s_lshr_b32 s3, s28, 1
    s_lshl_b32 s3, s3, 15
    v_add_u32 v13, s3, v13
    v_xor_b32 v14, 64, v13
    s_waitcnt vmcnt(0)
    s_barrier
    ds_read_b64_tr_b16 v[16:17], v13 offset:0
    ds_read_b64_tr_b16 v[18:19], v13 offset:1024
    ds_read_b64_tr_b16 v[20:21], v14 offset:0
    ds_read_b64_tr_b16 v[22:23], v14 offset:1024
    ds_read_b64_tr_b16 v[24:25], v13 offset:2048
    ds_read_b64_tr_b16 v[26:27], v13 offset:3072
    ds_read_b64_tr_b16 v[28:29], v14 offset:2048
    ds_read_b64_tr_b16 v[30:31], v14 offset:3072
    ds_read_b64_tr_b16 v[32:33], v13 offset:4096
    ds_read_b64_tr_b16 v[34:35], v13 offset:5120
    ds_read_b64_tr_b16 v[36:37], v14 offset:4096
    ds_read_b64_tr_b16 v[38:39], v14 offset:5120
    s_waitcnt lgkmcnt(0)
    ds_read_b64_tr_b16 v[40:41], v13 offset:6144
    ds_read_b64_tr_b16 v[42:43], v13 offset:7168
    ds_read_b64_tr_b16 v[44:45], v14 offset:6144
    ds_read_b64_tr_b16 v[46:47], v14 offset:7168
    ds_read_b64_tr_b16 v[48:49], v13 offset:8192
    ds_read_b64_tr_b16 v[50:51], v13 offset:9216
    ds_read_b64_tr_b16 v[52:53], v14 offset:8192
    ds_read_b64_tr_b16 v[54:55], v14 offset:9216
    ds_read_b64_tr_b16 v[56:57], v13 offset:10240
    ds_read_b64_tr_b16 v[58:59], v13 offset:11264
    ds_read_b64_tr_b16 v[60:61], v14 offset:10240
    ds_read_b64_tr_b16 v[62:63], v14 offset:11264
    s_waitcnt lgkmcnt(0)
    ds_read_b64_tr_b16 v[64:65], v13 offset:12288
    ds_read_b64_tr_b16 v[66:67], v13 offset:13312
    ds_read_b64_tr_b16 v[68:69], v14 offset:12288
    ds_read_b64_tr_b16 v[70:71], v14 offset:13312
    ds_read_b64_tr_b16 v[72:73], v13 offset:14336
    ds_read_b64_tr_b16 v[74:75], v13 offset:15360
    ds_read_b64_tr_b16 v[76:77], v14 offset:14336
    ds_read_b64_tr_b16 v[78:79], v14 offset:15360
    ds_read_b64_tr_b16 v[80:81], v13 offset:16384
    ds_read_b64_tr_b16 v[82:83], v13 offset:17408
    ds_read_b64_tr_b16 v[84:85], v14 offset:16384
    ds_read_b64_tr_b16 v[86:87], v14 offset:17408
    s_waitcnt lgkmcnt(0)
    ds_read_b64_tr_b16 v[88:89], v13 offset:18432
    ds_read_b64_tr_b16 v[90:91], v13 offset:19456
    ds_read_b64_tr_b16 v[92:93], v14 offset:18432
    ds_read_b64_tr_b16 v[94:95], v14 offset:19456
    ds_read_b64_tr_b16 v[96:97], v13 offset:20480
    ds_read_b64_tr_b16 v[98:99], v13 offset:21504
    ds_read_b64_tr_b16 v[100:101], v14 offset:20480
    ds_read_b64_tr_b16 v[102:103], v14 offset:21504
    ds_read_b64_tr_b16 v[104:105], v13 offset:22528
    ds_read_b64_tr_b16 v[106:107], v13 offset:23552
    ds_read_b64_tr_b16 v[108:109], v14 offset:22528
    ds_read_b64_tr_b16 v[110:111], v14 offset:23552
    s_waitcnt lgkmcnt(0)
    ds_read_b64_tr_b16 v[112:113], v13 offset:24576
    ds_read_b64_tr_b16 v[114:115], v13 offset:25600
    ds_read_b64_tr_b16 v[116:117], v14 offset:24576
    ds_read_b64_tr_b16 v[118:119], v14 offset:25600
    ds_read_b64_tr_b16 v[120:121], v13 offset:26624
    ds_read_b64_tr_b16 v[122:123], v13 offset:27648
    ds_read_b64_tr_b16 v[124:125], v14 offset:26624
    ds_read_b64_tr_b16 v[126:127], v14 offset:27648
    ds_read_b64_tr_b16 v[128:129], v13 offset:28672
    ds_read_b64_tr_b16 v[130:131], v13 offset:29696
    ds_read_b64_tr_b16 v[132:133], v14 offset:28672
    ds_read_b64_tr_b16 v[134:135], v14 offset:29696
    s_waitcnt lgkmcnt(0)
    ds_read_b64_tr_b16 v[136:137], v13 offset:30720
    ds_read_b64_tr_b16 v[138:139], v13 offset:31744
    ds_read_b64_tr_b16 v[140:141], v14 offset:30720
    ds_read_b64_tr_b16 v[142:143], v14 offset:31744
    s_mov_b32 s44, s22
    s_mov_b32 s45, s23
    s_mov_b32 s46, 2097152
    s_mov_b32 s47, 0x00020000
    s_lshl_b32 s61, s29, 16
    s_add_u32 s61, s61, 262144
    s_and_b32 s3, s28, 1
    s_lshl_b32 s3, s3, 15
    s_add_u32 s61, s61, s3
    s_add_u32 s60, s31, s3
    s_lshr_b32 s34, s28, 1
    s_lshl_b32 s3, s34, 14
    s_add_u32 s61, s61, s3
    s_lshl_b32 s3, s34, 6
    s_add_u32 s60, s60, s3
    s_lshl_b32 s3, s30, 7
    s_add_u32 s60, s60, s3
    v_and_b32 v12, 31, v0
    v_lshlrev_b32 v12, 10, v12
    v_lshrrev_b32 v13, 5, v0
    v_lshl_add_u32 v12, v13, 4, v12
    s_xor_b32 s3, s28, 2
    s_lshl_b32 s3, s3, 12
    v_lshl_add_u32 v14, v0, 4, s3
    s_lshl_b32 s3, s28, 12
    v_lshl_add_u32 v15, v0, 4, s3
    s_waitcnt lgkmcnt(0)
    s_barrier
    v_and_b32 v10, 15, v0
    v_lshlrev_b32 v10, 7, v10
    s_lshl_b32 s3, s29, 12
    s_lshr_b32 s34, s28, 1
    s_lshl_b32 s34, s34, 11
    s_add_u32 s3, s3, s34
    s_add_u32 s62, s3, 2490368
    s_mov_b32 s63, 0
L_O_poll:
    buffer_load_dwordx2 v[8:9], v10, s[52:55], s62 offen sc1
    s_waitcnt vmcnt(0)
    v_cmp_eq_u32 vcc, s32, v8
    v_cmp_eq_u32 s[34:35], s33, v9
    s_nop 1
    s_and_b64 vcc, vcc, s[34:35]
    s_cmp_eq_u64 vcc, -1
    s_cbranch_scc1 L_O_ok
    s_add_u32 s63, s63, 1
    s_cmp_lt_u32 s63, 200000
    s_cbranch_scc0 L_O_to
    s_sleep 1
    s_branch L_O_poll
L_O_to:
    v_mov_b32 v254, 4
    v_mov_b32 v255, 0
    s_mov_b32 s3, 11534272
    buffer_store_dword v254, v255, s[52:55], s3 offen sc1
L_O_ok:
    s_mov_b32 s63, 0
L_OD_first:
    s_add_u32 s3, s61, 0
    buffer_load_dwordx4 v[144:147], v2, s[52:55], s3 offen offset:0 sc1
    buffer_load_dwordx4 v[148:151], v2, s[52:55], s3 offen offset:1024 sc1
    buffer_load_dwordx4 v[152:155], v2, s[52:55], s3 offen offset:2048 sc1
    buffer_load_dwordx4 v[156:159], v2, s[52:55], s3 offen offset:3072 sc1
    s_waitcnt vmcnt(0)
    v_max3_u32 v8, v144, v145, v146
    v_max3_u32 v8, v8, v147, v148
    v_max3_u32 v8, v8, v149, v150
    v_max3_u32 v8, v8, v151, v152
    v_max3_u32 v8, v8, v153, v154
    v_max3_u32 v8, v8, v155, v156
    v_max3_u32 v8, v8, v157, v158
    v_max_u32 v8, v8, v159
    v_cmp_eq_u32 vcc, -1, v8
    s_nop 1
    s_cmp_lg_u64 vcc, 0
    s_cbranch_scc1 L_OD_retry
    s_add_u32 s3, s61, 4096
    buffer_load_dwordx4 v[160:163], v2, s[52:55], s3 offen offset:0 sc1
    buffer_load_dwordx4 v[164:167], v2, s[52:55], s3 offen offset:1024 sc1
    buffer_load_dwordx4 v[168:171], v2, s[52:55], s3 offen offset:2048 sc1
    buffer_load_dwordx4 v[172:175], v2, s[52:55], s3 offen offset:3072 sc1
    s_add_u32 s3, s61, 8192
    buffer_load_dwordx4 v[176:179], v2, s[52:55], s3 offen offset:0 sc1
    buffer_load_dwordx4 v[180:183], v2, s[52:55], s3 offen offset:1024 sc1
    buffer_load_dwordx4 v[184:187], v2, s[52:55], s3 offen offset:2048 sc1
    buffer_load_dwordx4 v[188:191], v2, s[52:55], s3 offen offset:3072 sc1
    s_add_u32 s3, s61, 12288
    buffer_load_dwordx4 v[192:195], v2, s[52:55], s3 offen offset:0 sc1
    buffer_load_dwordx4 v[196:199], v2, s[52:55], s3 offen offset:1024 sc1
    buffer_load_dwordx4 v[200:203], v2, s[52:55], s3 offen offset:2048 sc1
    buffer_load_dwordx4 v[204:207], v2, s[52:55], s3 offen offset:3072 sc1
    s_setprio 2
    v_mfma_f32_32x32x16_bf16 v[224:239], v[16:19], v[144:147], 0
    v_mfma_f32_32x32x16_bf16 v[240:255], v[20:23], v[144:147], 0
    v_mfma_f32_32x32x16_bf16 v[224:239], v[24:27], v[148:151], v[224:239]
    v_mfma_f32_32x32x16_bf16 v[240:255], v[28:31], v[148:151], v[240:255]
    v_mfma_f32_32x32x16_bf16 v[224:239], v[32:35], v[152:155], v[224:239]
    v_mfma_f32_32x32x16_bf16 v[240:255], v[36:39], v[152:155], v[240:255]
    v_mfma_f32_32x32x16_bf16 v[224:239], v[40:43], v[156:159], v[224:239]
    v_mfma_f32_32x32x16_bf16 v[240:255], v[44:47], v[156:159], v[240:255]
    s_waitcnt vmcnt(8)
    v_max3_u32 v8, v160, v161, v162
    v_max3_u32 v8, v8, v163, v164
    v_max3_u32 v8, v8, v165, v166
    v_max3_u32 v8, v8, v167, v168
    v_max3_u32 v8, v8, v169, v170
    v_max3_u32 v8, v8, v171, v172
    v_max3_u32 v8, v8, v173, v174
    v_max_u32 v8, v8, v175
    v_cmp_eq_u32 vcc, -1, v8
    s_nop 1
    s_cmp_lg_u64 vcc, 0
    s_cbranch_scc1 L_OD_drain
    v_mfma_f32_32x32x16_bf16 v[224:239], v[48:51], v[160:163], v[224:239]
    v_mfma_f32_32x32x16_bf16 v[240:255], v[52:55], v[160:163], v[240:255]
    v_mfma_f32_32x32x16_bf16 v[224:239], v[56:59], v[164:167], v[224:239]
    v_mfma_f32_32x32x16_bf16 v[240:255], v[60:63], v[164:167], v[240:255]
    v_mfma_f32_32x32x16_bf16 v[224:239], v[64:67], v[168:171], v[224:239]
    v_mfma_f32_32x32x16_bf16 v[240:255], v[68:71], v[168:171], v[240:255]
    v_mfma_f32_32x32x16_bf16 v[224:239], v[72:75], v[172:175], v[224:239]
    v_mfma_f32_32x32x16_bf16 v[240:255], v[76:79], v[172:175], v[240:255]
    s_waitcnt vmcnt(4)
    v_max3_u32 v8, v176, v177, v178
    v_max3_u32 v8, v8, v179, v180
    v_max3_u32 v8, v8, v181, v182
    v_max3_u32 v8, v8, v183, v184
    v_max3_u32 v8, v8, v185, v186
    v_max3_u32 v8, v8, v187, v188
    v_max3_u32 v8, v8, v189, v190
    v_max_u32 v8, v8, v191
    v_cmp_eq_u32 vcc, -1, v8
    s_nop 1
    s_cmp_lg_u64 vcc, 0
    s_cbranch_scc1 L_OD_drain
    v_mfma_f32_32x32x16_bf16 v[224:239], v[80:83], v[176:179], v[224:239]
    v_mfma_f32_32x32x16_bf16 v[240:255], v[84:87], v[176:179], v[240:255]
    v_mfma_f32_32x32x16_bf16 v[224:239], v[88:91], v[180:183], v[224:239]
    v_mfma_f32_32x32x16_bf16 v[240:255], v[92:95], v[180:183], v[240:255]
    v_mfma_f32_32x32x16_bf16 v[224:239], v[96:99], v[184:187], v[224:239]
    v_mfma_f32_32x32x16_bf16 v[240:255], v[100:103], v[184:187], v[240:255]
    v_mfma_f32_32x32x16_bf16 v[224:239], v[104:107], v[188:191], v[224:239]
    v_mfma_f32_32x32x16_bf16 v[240:255], v[108:111], v[188:191], v[240:255]
    s_waitcnt vmcnt(0)
    v_max3_u32 v8, v192, v193, v194
    v_max3_u32 v8, v8, v195, v196
    v_max3_u32 v8, v8, v197, v198
    v_max3_u32 v8, v8, v199, v200
    v_max3_u32 v8, v8, v201, v202
    v_max3_u32 v8, v8, v203, v204
    v_max3_u32 v8, v8, v205, v206
    v_max_u32 v8, v8, v207
    v_cmp_eq_u32 vcc, -1, v8
    s_nop 1
    s_cmp_lg_u64 vcc, 0
    s_cbranch_scc1 L_OD_drain
    v_mfma_f32_32x32x16_bf16 v[224:239], v[112:115], v[192:195], v[224:239]
    v_mfma_f32_32x32x16_bf16 v[240:255], v[116:119], v[192:195], v[240:255]
    v_mfma_f32_32x32x16_bf16 v[224:239], v[120:123], v[196:199], v[224:239]
    v_mfma_f32_32x32x16_bf16 v[240:255], v[124:127], v[196:199], v[240:255]
    v_mfma_f32_32x32x16_bf16 v[224:239], v[128:131], v[200:203], v[224:239]
    v_mfma_f32_32x32x16_bf16 v[240:255], v[132:135], v[200:203], v[240:255]
    v_mfma_f32_32x32x16_bf16 v[224:239], v[136:139], v[204:207], v[224:239]
    v_mfma_f32_32x32x16_bf16 v[240:255], v[140:143], v[204:207], v[240:255]
    s_branch L_OD_done
L_OD_drain:
    s_waitcnt vmcnt(0)
    s_setprio 0
L_OD_retry:
    s_add_u32 s63, s63, 1
    s_cmp_lt_u32 s63, 200000
    s_cbranch_scc0 L_OD_giveup
    s_sleep 1
    s_branch L_OD_first
L_OD_giveup:
    v_mov_b32 v254, 5
    v_mov_b32 v255, 0
    s_mov_b32 s3, 11534272
    buffer_store_dword v254, v255, s[52:55], s3 offen sc1
    s_add_u32 s3, s61, 0
    buffer_load_dwordx4 v[144:147], v2, s[52:55], s3 offen offset:0 sc1
    buffer_load_dwordx4 v[148:151], v2, s[52:55], s3 offen offset:1024 sc1
    buffer_load_dwordx4 v[152:155], v2, s[52:55], s3 offen offset:2048 sc1
    buffer_load_dwordx4 v[156:159], v2, s[52:55], s3 offen offset:3072 sc1
    s_add_u32 s3, s61, 4096
    buffer_load_dwordx4 v[160:163], v2, s[52:55], s3 offen offset:0 sc1
    buffer_load_dwordx4 v[164:167], v2, s[52:55], s3 offen offset:1024 sc1
    buffer_load_dwordx4 v[168:171], v2, s[52:55], s3 offen offset:2048 sc1
    buffer_load_dwordx4 v[172:175], v2, s[52:55], s3 offen offset:3072 sc1
    s_add_u32 s3, s61, 8192
    buffer_load_dwordx4 v[176:179], v2, s[52:55], s3 offen offset:0 sc1
    buffer_load_dwordx4 v[180:183], v2, s[52:55], s3 offen offset:1024 sc1
    buffer_load_dwordx4 v[184:187], v2, s[52:55], s3 offen offset:2048 sc1
    buffer_load_dwordx4 v[188:191], v2, s[52:55], s3 offen offset:3072 sc1
    s_add_u32 s3, s61, 12288
    buffer_load_dwordx4 v[192:195], v2, s[52:55], s3 offen offset:0 sc1
    buffer_load_dwordx4 v[196:199], v2, s[52:55], s3 offen offset:1024 sc1
    buffer_load_dwordx4 v[200:203], v2, s[52:55], s3 offen offset:2048 sc1
    buffer_load_dwordx4 v[204:207], v2, s[52:55], s3 offen offset:3072 sc1
    s_waitcnt vmcnt(0)
    v_mfma_f32_32x32x16_bf16 v[224:239], v[16:19], v[144:147], 0
    v_mfma_f32_32x32x16_bf16 v[240:255], v[20:23], v[144:147], 0
    v_mfma_f32_32x32x16_bf16 v[224:239], v[24:27], v[148:151], v[224:239]
    v_mfma_f32_32x32x16_bf16 v[240:255], v[28:31], v[148:151], v[240:255]
    v_mfma_f32_32x32x16_bf16 v[224:239], v[32:35], v[152:155], v[224:239]
    v_mfma_f32_32x32x16_bf16 v[240:255], v[36:39], v[152:155], v[240:255]
    v_mfma_f32_32x32x16_bf16 v[224:239], v[40:43], v[156:159], v[224:239]
    v_mfma_f32_32x32x16_bf16 v[240:255], v[44:47], v[156:159], v[240:255]
    v_mfma_f32_32x32x16_bf16 v[224:239], v[48:51], v[160:163], v[224:239]
    v_mfma_f32_32x32x16_bf16 v[240:255], v[52:55], v[160:163], v[240:255]
    v_mfma_f32_32x32x16_bf16 v[224:239], v[56:59], v[164:167], v[224:239]
    v_mfma_f32_32x32x16_bf16 v[240:255], v[60:63], v[164:167], v[240:255]
    v_mfma_f32_32x32x16_bf16 v[224:239], v[64:67], v[168:171], v[224:239]
    v_mfma_f32_32x32x16_bf16 v[240:255], v[68:71], v[168:171], v[240:255]
    v_mfma_f32_32x32x16_bf16 v[224:239], v[72:75], v[172:175], v[224:239]
    v_mfma_f32_32x32x16_bf16 v[240:255], v[76:79], v[172:175], v[240:255]
    v_mfma_f32_32x32x16_bf16 v[224:239], v[80:83], v[176:179], v[224:239]
    v_mfma_f32_32x32x16_bf16 v[240:255], v[84:87], v[176:179], v[240:255]
    v_mfma_f32_32x32x16_bf16 v[224:239], v[88:91], v[180:183], v[224:239]
    v_mfma_f32_32x32x16_bf16 v[240:255], v[92:95], v[180:183], v[240:255]
    v_mfma_f32_32x32x16_bf16 v[224:239], v[96:99], v[184:187], v[224:239]
    v_mfma_f32_32x32x16_bf16 v[240:255], v[100:103], v[184:187], v[240:255]
    v_mfma_f32_32x32x16_bf16 v[224:239], v[104:107], v[188:191], v[224:239]
    v_mfma_f32_32x32x16_bf16 v[240:255], v[108:111], v[188:191], v[240:255]
    v_mfma_f32_32x32x16_bf16 v[224:239], v[112:115], v[192:195], v[224:239]
    v_mfma_f32_32x32x16_bf16 v[240:255], v[116:119], v[192:195], v[240:255]
    v_mfma_f32_32x32x16_bf16 v[224:239], v[120:123], v[196:199], v[224:239]
    v_mfma_f32_32x32x16_bf16 v[240:255], v[124:127], v[196:199], v[240:255]
    v_mfma_f32_32x32x16_bf16 v[224:239], v[128:131], v[200:203], v[224:239]
    v_mfma_f32_32x32x16_bf16 v[240:255], v[132:135], v[200:203], v[240:255]
    v_mfma_f32_32x32x16_bf16 v[224:239], v[136:139], v[204:207], v[224:239]
    v_mfma_f32_32x32x16_bf16 v[240:255], v[140:143], v[204:207], v[240:255]
L_OD_done:
    s_cmp_ge_u32 s28, 2
    s_cbranch_scc1 L_T_hi
    s_nop 9
    ds_write_b128 v14, v[240:243] offset:0
    ds_write_b128 v14, v[244:247] offset:1024
    ds_write_b128 v14, v[248:251] offset:2048
    ds_write_b128 v14, v[252:255] offset:3072
    v_sub_f32 v224, v224, v208
    v_sub_f32 v225, v225, v209
    v_sub_f32 v226, v226, v210
    v_sub_f32 v227, v227, v211
    v_sub_f32 v228, v228, v212
    v_sub_f32 v229, v229, v213
    v_sub_f32 v230, v230, v214
    v_sub_f32 v231, v231, v215
    v_sub_f32 v232, v232, v216
    v_sub_f32 v233, v233, v217
    v_sub_f32 v234, v234, v218
    v_sub_f32 v235, v235, v219
    v_sub_f32 v236, v236, v220
    v_sub_f32 v237, v237, v221
    v_sub_f32 v238, v238, v222
    v_sub_f32 v239, v239, v223
    s_waitcnt lgkmcnt(0)
    s_barrier
    ds_read_b128 v[16:19], v15 offset:0
    ds_read_b128 v[20:23], v15 offset:1024
    ds_read_b128 v[24:27], v15 offset:2048
    ds_read_b128 v[28:31], v15 offset:3072
    s_waitcnt lgkmcnt(0)
    v_add_f32 v16, v16, v224
    v_add_f32 v17, v17, v225
    v_add_f32 v18, v18, v226
    v_add_f32 v19, v19, v227
    v_add_f32 v20, v20, v228
    v_add_f32 v21, v21, v229
    v_add_f32 v22, v22, v230
    v_add_f32 v23, v23, v231
    v_add_f32 v24, v24, v232
    v_add_f32 v25, v25, v233
    v_add_f32 v26, v26, v234
    v_add_f32 v27, v27, v235
    v_add_f32 v28, v28, v236
    v_add_f32 v29, v29, v237
    v_add_f32 v30, v30, v238
    v_add_f32 v31, v31, v239
    s_branch L_T_join
L_T_hi:
    s_nop 9
    ds_write_b128 v14, v[224:227] offset:0
    ds_write_b128 v14, v[228:231] offset:1024
    ds_write_b128 v14, v[232:235] offset:2048
    ds_write_b128 v14, v[236:239] offset:3072
    v_sub_f32 v240, v240, v208
    v_sub_f32 v241, v241, v209
    v_sub_f32 v242, v242, v210
    v_sub_f32 v243, v243, v211
    v_sub_f32 v244, v244, v212
    v_sub_f32 v245, v245, v213
    v_sub_f32 v246, v246, v214
    v_sub_f32 v247, v247, v215
    v_sub_f32 v248, v248, v216
    v_sub_f32 v249, v249, v217
    v_sub_f32 v250, v250, v218
    v_sub_f32 v251, v251, v219
    v_sub_f32 v252, v252, v220
    v_sub_f32 v253, v253, v221
    v_sub_f32 v254, v254, v222
    v_sub_f32 v255, v255, v223
    s_waitcnt lgkmcnt(0)
    s_barrier
    ds_read_b128 v[16:19], v15 offset:0
    ds_read_b128 v[20:23], v15 offset:1024
    ds_read_b128 v[24:27], v15 offset:2048
    ds_read_b128 v[28:31], v15 offset:3072
    s_waitcnt lgkmcnt(0)
    v_add_f32 v16, v16, v240
    v_add_f32 v17, v17, v241
    v_add_f32 v18, v18, v242
    v_add_f32 v19, v19, v243
    v_add_f32 v20, v20, v244
    v_add_f32 v21, v21, v245
    v_add_f32 v22, v22, v246
    v_add_f32 v23, v23, v247
    v_add_f32 v24, v24, v248
    v_add_f32 v25, v25, v249
    v_add_f32 v26, v26, v250
    v_add_f32 v27, v27, v251
    v_add_f32 v28, v28, v252
    v_add_f32 v29, v29, v253
    v_add_f32 v30, v30, v254
    v_add_f32 v31, v31, v255
L_T_join:
    v_fma_f32 v16, v16, v4, v208
    v_fma_f32 v17, v17, v4, v209
    v_fma_f32 v18, v18, v4, v210
    v_fma_f32 v19, v19, v4, v211
    v_fma_f32 v20, v20, v4, v212
    v_fma_f32 v21, v21, v4, v213
    v_fma_f32 v22, v22, v4, v214
    v_fma_f32 v23, v23, v4, v215
    v_fma_f32 v24, v24, v4, v216
    v_fma_f32 v25, v25, v4, v217
    v_fma_f32 v26, v26, v4, v218
    v_fma_f32 v27, v27, v4, v219
    v_fma_f32 v28, v28, v4, v220
    v_fma_f32 v29, v29, v4, v221
    v_fma_f32 v30, v30, v4, v222
    v_fma_f32 v31, v31, v4, v223
    v_cvt_pk_bf16_f32 v80, v16, v17
    v_cvt_pk_bf16_f32 v81, v18, v19
    v_cvt_pk_bf16_f32 v82, v20, v21
    v_cvt_pk_bf16_f32 v83, v22, v23
    v_cvt_pk_bf16_f32 v84, v24, v25
    v_cvt_pk_bf16_f32 v85, v26, v27
    v_cvt_pk_bf16_f32 v86, v28, v29
    v_cvt_pk_bf16_f32 v87, v30, v31
    s_nop 1
    v_permlane32_swap_b32 v80, v82
    v_permlane32_swap_b32 v81, v83
    v_permlane32_swap_b32 v84, v86
    v_permlane32_swap_b32 v85, v87
    buffer_store_dwordx4 v[80:83], v12, s[44:47], s60 offen
    buffer_store_dwordx4 v[84:87], v12, s[44:47], s60 offen offset:32
    s_endpgm
L_A:
    s_mov_b32 s79, s35
    v_mov_b32 v251, v0
    s_setprio 2
    s_mov_b32 s36, s4
    s_mov_b32 s37, s5
    s_mov_b32 s38, 2097152
    s_mov_b32 s39, 0x00020000
    s_mov_b32 s40, s6
    s_mov_b32 s41, s7
    s_mov_b32 s42, 524288
    s_mov_b32 s43, 0x00020000
    v_lshrrev_b32 v10, 3, v251
    v_lshlrev_b32 v10, 10, v10
    v_and_b32 v11, 7, v251
    v_lshrrev_b32 v12, 4, v251
    v_xor_b32 v13, v11, v12
    v_lshl_add_u32 v229, v13, 4, v10
    v_xor_b32 v13, 4, v13
    v_lshl_add_u32 v230, v13, 4, v10
    v_add_u32 v230, 7168, v230
    v_and_b32 v12, 1, v12
    v_lshlrev_b32 v12, 2, v12
    v_xor_b32 v13, v11, v12
    v_lshl_add_u32 v231, v13, 4, v10
    v_add_u32 v254, 7168, v231
    s_lshl_b32 s3, s28, 14
    s_add_u32 s63, s31, s3
    s_lshl_b32 s34, s30, 7
    s_add_u32 s64, s3, s34
    s_lshl_b32 s65, s28, 11
    s_add_u32 m0, s65, 0
    s_nop 0
    buffer_load_dwordx4 v229, s[36:39], s63 offen lds
    buffer_load_dwordx4 v230, s[36:39], s63 offen offset:1024 lds
    s_add_u32 m0, s65, 8192
    s_add_u32 s63, s63, 128
    buffer_load_dwordx4 v231, s[40:43], s64 offen lds
    buffer_load_dwordx4 v254, s[40:43], s64 offen offset:1024 lds
    s_add_u32 s64, s64, 65536
    s_add_u32 m0, s65, 16384
    s_nop 0
    buffer_load_dwordx4 v229, s[36:39], s63 offen lds
    buffer_load_dwordx4 v230, s[36:39], s63 offen offset:1024 lds
    s_add_u32 m0, s65, 24576
    s_add_u32 s63, s63, 128
    buffer_load_dwordx4 v231, s[40:43], s64 offen lds
    buffer_load_dwordx4 v254, s[40:43], s64 offen offset:1024 lds
    s_add_u32 s64, s64, 65536
    s_add_u32 m0, s65, 32768
    s_nop 0
    buffer_load_dwordx4 v229, s[36:39], s63 offen lds
    buffer_load_dwordx4 v230, s[36:39], s63 offen offset:1024 lds
    s_add_u32 m0, s65, 40960
    s_add_u32 s63, s63, 128
    buffer_load_dwordx4 v231, s[40:43], s64 offen lds
    buffer_load_dwordx4 v254, s[40:43], s64 offen offset:1024 lds
    s_add_u32 s64, s64, 65536
    s_add_u32 m0, s65, 49152
    s_nop 0
    buffer_load_dwordx4 v229, s[36:39], s63 offen lds
    buffer_load_dwordx4 v230, s[36:39], s63 offen offset:1024 lds
    s_add_u32 m0, s65, 57344
    s_add_u32 s63, s63, 128
    buffer_load_dwordx4 v231, s[40:43], s64 offen lds
    buffer_load_dwordx4 v254, s[40:43], s64 offen offset:1024 lds
    s_add_u32 s64, s64, 65536
    v_lshlrev_b32 v249, 4, v251
    v_mov_b32 v240, -1
    v_mov_b32 v241, -1
    v_mov_b32 v242, -1
    v_mov_b32 v243, -1
    s_lshl_b32 s3, s29, 6
    s_lshl_b32 s34, s30, 2
    s_add_u32 s34, s34, s28
    s_add_u32 s3, s3, s34
    s_lshl_b32 s3, s3, 10
    s_add_u32 s61, s3, 262144
    s_lshl_b32 s3, s29, 12
    s_lshl_b32 s34, s34, 7
    s_add_u32 s3, s3, s34
    s_add_u32 s62, s3, 2490368
    s_lshr_b32 s3, s2, 3
    s_lshl_b32 s3, s3, 2
    s_add_u32 s68, s3, s28
    s_cmp_ge_u32 s68, 208
    s_cbranch_scc1 L_pfd_12
    s_cmp_ge_u32 s68, 96
    s_cbranch_scc1 L_pfw1_10
    s_cmp_ge_u32 s68, 64
    s_cbranch_scc1 L_pfwq_11
    s_lshr_b32 s3, s29, 3
    s_lshl_b32 s3, s3, 19
    s_lshl_b32 s34, s68, 13
    s_add_u32 s3, s3, s34
    v_lshlrev_b32 v245, 7, v251
    s_mov_b32 s48, s4
    s_mov_b32 s49, s5
    s_mov_b32 s50, 2097152
    s_mov_b32 s51, 0x00020000
    buffer_load_dword v244, v245, s[48:51], s3 offen
    s_branch L_pfd_12
L_pfwq_11:
    s_sub_u32 s3, s68, 64
    s_lshl_b32 s3, s3, 14
    s_lshr_b32 s34, s30, 2
    s_lshl_b32 s34, s34, 9
    s_add_u32 s3, s3, s34
    v_lshrrev_b32 v245, 2, v251
    v_lshlrev_b32 v245, 10, v245
    v_and_b32 v246, 3, v251
    v_lshl_add_u32 v245, v246, 7, v245
    s_mov_b32 s48, s6
    s_mov_b32 s49, s7
    s_mov_b32 s50, 524288
    s_mov_b32 s51, 0x00020000
    buffer_load_dword v244, v245, s[48:51], s3 offen
    s_branch L_pfd_12
L_pfw1_10:
    s_sub_u32 s3, s68, 96
    s_lshl_b32 s3, s3, 6
    v_add_u32 v245, s3, v251
    s_mov_b32 s34, 37450
    v_mul_lo_u32 v246, v245, s34
    v_lshrrev_b32 v246, 19, v246
    v_mul_u32_u24 v247, 14, v246
    v_sub_u32 v245, v245, v247
    v_lshlrev_b32 v245, 7, v245
    s_movk_i32 s34, 3584
    v_mul_lo_u32 v246, v246, s34
    v_add_u32 v245, v245, v246
    s_lshr_b32 s34, s30, 2
    s_mul_i32 s3, s34, 1792
    s_mov_b32 s48, s16
    s_mov_b32 s49, s17
    s_mov_b32 s50, 1835008
    s_mov_b32 s51, 0x00020000
    buffer_load_dword v244, v245, s[48:51], s3 offen
L_pfd_12:
    v_and_b32 v10, 31, v251
    v_lshrrev_b32 v11, 5, v251
    v_and_b32 v12, 15, v251
    v_bfe_u32 v13, v251, 4, 1
    s_lshr_b32 s3, s28, 1
    s_lshl_b32 s3, s3, 12
    v_lshl_add_u32 v14, v10, 7, s3
    v_bfe_u32 v15, v10, 1, 3
    v_add_u32 v9, 0, v11
    v_xor_b32 v9, v9, v15
    v_lshl_add_u32 v224, v9, 4, v14
    v_add_u32 v9, 2, v11
    v_xor_b32 v9, v9, v15
    v_lshl_add_u32 v225, v9, 4, v14
    v_add_u32 v9, 4, v11
    v_xor_b32 v9, v9, v15
    v_lshl_add_u32 v226, v9, 4, v14
    v_add_u32 v9, 6, v11
    v_xor_b32 v9, v9, v15
    v_lshl_add_u32 v227, v9, 4, v14
    v_lshrrev_b32 v14, 2, v12
    v_lshl_add_u32 v14, v11, 3, v14
    v_lshlrev_b32 v14, 7, v14
    s_and_b32 s3, s28, 1
    s_lshl_b32 s3, s3, 2
    v_bfe_u32 v15, v12, 1, 1
    v_lshl_add_u32 v15, v13, 1, v15
    v_add_u32 v15, s3, v15
    v_bfe_u32 v9, v12, 3, 1
    v_lshlrev_b32 v9, 2, v9
    v_xor_b32 v15, v15, v9
    v_lshl_add_u32 v14, v15, 4, v14
    v_and_b32 v15, 1, v12
    v_lshl_add_u32 v14, v15, 3, v14
    v_add_u32 v228, 8192, v14
    v_lshlrev_b32 v249, 4, v251
    v_lshlrev_b32 v250, 8, v11
    v_lshl_add_u32 v250, v12, 4, v250
    v_mov_b32 v248, 0xdddddddd
    v_cmp_eq_u32 vcc, 16, v10
    v_mov_b32 v9, 0x3f803f80
    s_nop 0
    v_cndmask_b32 v232, 0, v9, vcc
    v_cndmask_b32 v233, 0, v9, vcc
    v_cndmask_b32 v234, 0, v9, vcc
    v_cndmask_b32 v235, 0, v9, vcc
    s_setprio 0
    v_mov_b32 v0, 0
    v_mov_b32 v1, 0
    v_mov_b32 v2, 0
    v_mov_b32 v3, 0
    v_mov_b32 v4, 0
    v_mov_b32 v5, 0
    v_mov_b32 v6, 0
    v_mov_b32 v7, 0
    v_mov_b32 v8, 0
    v_mov_b32 v9, 0
    v_mov_b32 v10, 0
    v_mov_b32 v11, 0
    v_mov_b32 v12, 0
    v_mov_b32 v13, 0
    v_mov_b32 v14, 0
    v_mov_b32 v15, 0
    v_mov_b32 v16, 0
    v_mov_b32 v17, 0
    v_mov_b32 v18, 0
    v_mov_b32 v19, 0
    v_mov_b32 v20, 0
    v_mov_b32 v21, 0
    v_mov_b32 v22, 0
    v_mov_b32 v23, 0
    v_mov_b32 v24, 0
    v_mov_b32 v25, 0
    v_mov_b32 v26, 0
    v_mov_b32 v27, 0
    v_mov_b32 v28, 0
    v_mov_b32 v29, 0
    v_mov_b32 v30, 0
    v_mov_b32 v31, 0
    v_mov_b32 v32, 0
    v_mov_b32 v33, 0
    v_mov_b32 v34, 0
    v_mov_b32 v35, 0
    v_mov_b32 v36, 0
    v_mov_b32 v37, 0
    v_mov_b32 v38, 0
    v_mov_b32 v39, 0
    v_mov_b32 v40, 0
    v_mov_b32 v41, 0
    v_mov_b32 v42, 0
    v_mov_b32 v43, 0
    v_mov_b32 v44, 0
    v_mov_b32 v45, 0
    v_mov_b32 v46, 0
    v_mov_b32 v47, 0
    v_mov_b32 v48, 0
    v_mov_b32 v49, 0
    v_mov_b32 v50, 0
    v_mov_b32 v51, 0
    v_mov_b32 v52, 0
    v_mov_b32 v53, 0
    v_mov_b32 v54, 0
    v_mov_b32 v55, 0
    v_mov_b32 v56, 0
    v_mov_b32 v57, 0
    v_mov_b32 v58, 0
    v_mov_b32 v59, 0
    v_mov_b32 v60, 0
    v_mov_b32 v61, 0
    v_mov_b32 v62, 0
    v_mov_b32 v63, 0
    v_mov_b32 v64, 0
    v_mov_b32 v65, 0
    v_mov_b32 v66, 0
    v_mov_b32 v67, 0
    v_mov_b32 v68, 0
    v_mov_b32 v69, 0
    v_mov_b32 v70, 0
    v_mov_b32 v71, 0
    v_mov_b32 v72, 0
    v_mov_b32 v73, 0
    v_mov_b32 v74, 0
    v_mov_b32 v75, 0
    v_mov_b32 v76, 0
    v_mov_b32 v77, 0
    v_mov_b32 v78, 0
    v_mov_b32 v79, 0
    v_mov_b32 v80, 0
    v_mov_b32 v81, 0
    v_mov_b32 v82, 0
    v_mov_b32 v83, 0
    v_mov_b32 v84, 0
    v_mov_b32 v85, 0
    v_mov_b32 v86, 0
    v_mov_b32 v87, 0
    v_mov_b32 v88, 0
    v_mov_b32 v89, 0
    v_mov_b32 v90, 0
    v_mov_b32 v91, 0
    v_mov_b32 v92, 0
    v_mov_b32 v93, 0
    v_mov_b32 v94, 0
    v_mov_b32 v95, 0
    v_mov_b32 v96, 0
    v_mov_b32 v97, 0
    v_mov_b32 v98, 0
    v_mov_b32 v99, 0
    v_mov_b32 v100, 0
    v_mov_b32 v101, 0
    v_mov_b32 v102, 0
    v_mov_b32 v103, 0
    v_mov_b32 v104, 0
    v_mov_b32 v105, 0
    v_mov_b32 v106, 0
    v_mov_b32 v107, 0
    v_mov_b32 v108, 0
    v_mov_b32 v109, 0
    v_mov_b32 v110, 0
    v_mov_b32 v111, 0
    v_mov_b32 v112, 0
    v_mov_b32 v113, 0
    v_mov_b32 v114, 0
    v_mov_b32 v115, 0
    v_mov_b32 v116, 0
    v_mov_b32 v117, 0
    v_mov_b32 v118, 0
    v_mov_b32 v119, 0
    v_mov_b32 v120, 0
    v_mov_b32 v121, 0
    v_mov_b32 v122, 0
    v_mov_b32 v123, 0
    v_mov_b32 v124, 0
    v_mov_b32 v125, 0
    v_mov_b32 v126, 0
    v_mov_b32 v127, 0
    s_setprio 2
    s_waitcnt vmcnt(12)
    s_barrier
    v_readfirstlane_b32 s32, v253
    s_nop 0
    s_add_u32 s32, s32, 1
    s_not_b32 s33, s32
    s_cmp_lg_u32 s28, 0
    s_cbranch_scc1 L_nostart_13
    v_mov_b32 v236, s32
    v_mov_b32 v237, s33
    v_mov_b32 v238, 0
    s_lshl_b32 s3, s2, 3
    s_add_u32 s3, s3, 16384
    s_mov_b64 exec, 1
    buffer_store_dwordx2 v[236:237], v238, s[52:55], s3 offen sc1
    s_mov_b64 exec, -1
L_nostart_13:
    ds_read_b128 v[128:131], v224 offset:0
    ds_read_b64_tr_b16 v[144:145], v228 offset:0
    ds_read_b64_tr_b16 v[146:147], v228 offset:512
    ds_read_b128 v[132:135], v225 offset:0
    ds_read_b64_tr_b16 v[148:149], v228 offset:2048
    ds_read_b64_tr_b16 v[150:151], v228 offset:2560
    ds_read_b128 v[136:139], v226 offset:0
    ds_read_b64_tr_b16 v[152:153], v228 offset:4096
    ds_read_b64_tr_b16 v[154:155], v228 offset:4608
    ds_read_b128 v[140:143], v227 offset:0
    ds_read_b64_tr_b16 v[156:157], v228 offset:6144
    ds_read_b64_tr_b16 v[158:159], v228 offset:6656
    s_waitcnt lgkmcnt(0)
    s_waitcnt vmcnt(8)
    s_barrier
    s_add_u32 m0, s65, 0
    v_mfma_f32_32x32x16_bf16 v[192:207], v[144:147], v[128:131], 0
    buffer_load_dwordx4 v229, s[36:39], s63 offen lds
    ds_read_b128 v[160:163], v224 offset:16384
    ds_read_b64_tr_b16 v[176:177], v228 offset:16384
    ds_read_b64_tr_b16 v[178:179], v228 offset:16896
    v_mfma_f32_32x32x16_bf16 v[192:207], v[148:151], v[132:135], v[192:207]
    buffer_load_dwordx4 v230, s[36:39], s63 offen offset:1024 lds
    s_add_u32 m0, s65, 8192
    s_add_u32 s63, s63, 128
    ds_read_b128 v[164:167], v225 offset:16384
    ds_read_b64_tr_b16 v[180:181], v228 offset:18432
    ds_read_b64_tr_b16 v[182:183], v228 offset:18944
    v_mfma_f32_32x32x16_bf16 v[192:207], v[152:155], v[136:139], v[192:207]
    buffer_load_dwordx4 v231, s[40:43], s64 offen lds
    ds_read_b128 v[168:171], v226 offset:16384
    ds_read_b64_tr_b16 v[184:185], v228 offset:20480
    ds_read_b64_tr_b16 v[186:187], v228 offset:20992
    v_mfma_f32_32x32x16_bf16 v[192:207], v[156:159], v[140:143], v[192:207]
    buffer_load_dwordx4 v254, s[40:43], s64 offen offset:1024 lds
    s_add_u32 s64, s64, 65536
    ds_read_b128 v[172:175], v227 offset:16384
    ds_read_b64_tr_b16 v[188:189], v228 offset:22528
    ds_read_b64_tr_b16 v[190:191], v228 offset:23040
    s_waitcnt lgkmcnt(0)
    s_waitcnt vmcnt(8)
    s_barrier
    s_add_u32 m0, s65, 16384
    v_mfma_f32_32x32x16_bf16 v[192:207], v[176:179], v[160:163], v[192:207]
    buffer_load_dwordx4 v229, s[36:39], s63 offen lds
    ds_read_b128 v[128:131], v224 offset:32768
    ds_read_b64_tr_b16 v[144:145], v228 offset:32768
    ds_read_b64_tr_b16 v[146:147], v228 offset:33280
    v_mfma_f32_32x32x16_bf16 v[192:207], v[180:183], v[164:167], v[192:207]
    buffer_load_dwordx4 v230, s[36:39], s63 offen offset:1024 lds
    s_add_u32 m0, s65, 24576
    s_add_u32 s63, s63, 128
    ds_read_b128 v[132:135], v225 offset:32768
    ds_read_b64_tr_b16 v[148:149], v228 offset:34816
    ds_read_b64_tr_b16 v[150:151], v228 offset:35328
    v_mfma_f32_32x32x16_bf16 v[192:207], v[184:187], v[168:171], v[192:207]
    buffer_load_dwordx4 v231, s[40:43], s64 offen lds
    ds_read_b128 v[136:139], v226 offset:32768
    ds_read_b64_tr_b16 v[152:153], v228 offset:36864
    ds_read_b64_tr_b16 v[154:155], v228 offset:37376
    v_mfma_f32_32x32x16_bf16 v[192:207], v[188:191], v[172:175], v[192:207]
    buffer_load_dwordx4 v254, s[40:43], s64 offen offset:1024 lds
    s_add_u32 s64, s64, 65536
    ds_read_b128 v[140:143], v227 offset:32768
    ds_read_b64_tr_b16 v[156:157], v228 offset:38912
    ds_read_b64_tr_b16 v[158:159], v228 offset:39424
    s_waitcnt lgkmcnt(0)
    s_waitcnt vmcnt(8)
    s_barrier
    s_add_u32 m0, s65, 32768
    v_mfma_f32_32x32x16_bf16 v[192:207], v[144:147], v[128:131], v[192:207]
    buffer_load_dwordx4 v229, s[36:39], s63 offen lds
    ds_read_b128 v[160:163], v224 offset:49152
    ds_read_b64_tr_b16 v[176:177], v228 offset:49152
    ds_read_b64_tr_b16 v[178:179], v228 offset:49664
    v_mfma_f32_32x32x16_bf16 v[192:207], v[148:151], v[132:135], v[192:207]
    buffer_load_dwordx4 v230, s[36:39], s63 offen offset:1024 lds
    s_add_u32 m0, s65, 40960
    s_add_u32 s63, s63, 128
    ds_read_b128 v[164:167], v225 offset:49152
    ds_read_b64_tr_b16 v[180:181], v228 offset:51200
    ds_read_b64_tr_b16 v[182:183], v228 offset:51712
    v_mfma_f32_32x32x16_bf16 v[192:207], v[152:155], v[136:139], v[192:207]
    buffer_load_dwordx4 v231, s[40:43], s64 offen lds
    ds_read_b128 v[168:171], v226 offset:49152
    ds_read_b64_tr_b16 v[184:185], v228 offset:53248
    ds_read_b64_tr_b16 v[186:187], v228 offset:53760
    v_mfma_f32_32x32x16_bf16 v[192:207], v[156:159], v[140:143], v[192:207]
    buffer_load_dwordx4 v254, s[40:43], s64 offen offset:1024 lds
    s_add_u32 s64, s64, 65536
    ds_read_b128 v[172:175], v227 offset:49152
    ds_read_b64_tr_b16 v[188:189], v228 offset:55296
    ds_read_b64_tr_b16 v[190:191], v228 offset:55808
    s_waitcnt lgkmcnt(0)
    s_waitcnt vmcnt(8)
    s_barrier
    s_add_u32 m0, s65, 49152
    v_mfma_f32_32x32x16_bf16 v[192:207], v[176:179], v[160:163], v[192:207]
    buffer_load_dwordx4 v229, s[36:39], s63 offen lds
    ds_read_b128 v[128:131], v224 offset:0
    ds_read_b64_tr_b16 v[144:145], v228 offset:0
    ds_read_b64_tr_b16 v[146:147], v228 offset:512
    v_mfma_f32_32x32x16_bf16 v[192:207], v[180:183], v[164:167], v[192:207]
    buffer_load_dwordx4 v230, s[36:39], s63 offen offset:1024 lds
    s_add_u32 m0, s65, 57344
    s_add_u32 s63, s63, 128
    ds_read_b128 v[132:135], v225 offset:0
    ds_read_b64_tr_b16 v[148:149], v228 offset:2048
    ds_read_b64_tr_b16 v[150:151], v228 offset:2560
    v_mfma_f32_32x32x16_bf16 v[192:207], v[184:187], v[168:171], v[192:207]
    buffer_load_dwordx4 v231, s[40:43], s64 offen lds
    ds_read_b128 v[136:139], v226 offset:0
    ds_read_b64_tr_b16 v[152:153], v228 offset:4096
    ds_read_b64_tr_b16 v[154:155], v228 offset:4608
    v_mfma_f32_32x32x16_bf16 v[192:207], v[188:191], v[172:175], v[192:207]
    buffer_load_dwordx4 v254, s[40:43], s64 offen offset:1024 lds
    s_add_u32 s64, s64, 65536
    ds_read_b128 v[140:143], v227 offset:0
    ds_read_b64_tr_b16 v[156:157], v228 offset:6144
    ds_read_b64_tr_b16 v[158:159], v228 offset:6656
    s_waitcnt lgkmcnt(0)
    s_waitcnt vmcnt(8)
    s_barrier
    v_mfma_f32_32x32x16_bf16 v[192:207], v[144:147], v[128:131], v[192:207]
    ds_read_b128 v[160:163], v224 offset:16384
    ds_read_b64_tr_b16 v[176:177], v228 offset:16384
    ds_read_b64_tr_b16 v[178:179], v228 offset:16896
    v_mfma_f32_32x32x16_bf16 v[192:207], v[148:151], v[132:135], v[192:207]
    ds_read_b128 v[164:167], v225 offset:16384
    ds_read_b64_tr_b16 v[180:181], v228 offset:18432
    ds_read_b64_tr_b16 v[182:183], v228 offset:18944
    v_mfma_f32_32x32x16_bf16 v[192:207], v[152:155], v[136:139], v[192:207]
    ds_read_b128 v[168:171], v226 offset:16384
    ds_read_b64_tr_b16 v[184:185], v228 offset:20480
    ds_read_b64_tr_b16 v[186:187], v228 offset:20992
    v_mfma_f32_32x32x16_bf16 v[192:207], v[156:159], v[140:143], v[192:207]
    ds_read_b128 v[172:175], v227 offset:16384
    ds_read_b64_tr_b16 v[188:189], v228 offset:22528
    ds_read_b64_tr_b16 v[190:191], v228 offset:23040
    s_waitcnt lgkmcnt(0)
    s_waitcnt vmcnt(4)
    s_barrier
    v_mfma_f32_32x32x16_bf16 v[192:207], v[176:179], v[160:163], v[192:207]
    ds_read_b128 v[128:131], v224 offset:32768
    ds_read_b64_tr_b16 v[144:145], v228 offset:32768
    ds_read_b64_tr_b16 v[146:147], v228 offset:33280
    v_mfma_f32_32x32x16_bf16 v[192:207], v[180:183], v[164:167], v[192:207]
    ds_read_b128 v[132:135], v225 offset:32768
    ds_read_b64_tr_b16 v[148:149], v228 offset:34816
    ds_read_b64_tr_b16 v[150:151], v228 offset:35328
    v_mfma_f32_32x32x16_bf16 v[192:207], v[184:187], v[168:171], v[192:207]
    ds_read_b128 v[136:139], v226 offset:32768
    ds_read_b64_tr_b16 v[152:153], v228 offset:36864
    ds_read_b64_tr_b16 v[154:155], v228 offset:37376
    v_mfma_f32_32x32x16_bf16 v[192:207], v[188:191], v[172:175], v[192:207]
    ds_read_b128 v[140:143], v227 offset:32768
    ds_read_b64_tr_b16 v[156:157], v228 offset:38912
    ds_read_b64_tr_b16 v[158:159], v228 offset:39424
    s_waitcnt lgkmcnt(0)
    s_waitcnt vmcnt(0)
    s_barrier
    s_add_u32 s3, s61, 32768
    buffer_store_dwordx4 v[240:243], v249, s[52:55], s61 offen sc1
    buffer_store_dwordx4 v[240:243], v249, s[52:55], s3 offen sc1
    v_mfma_f32_32x32x16_bf16 v[192:207], v[144:147], v[128:131], v[192:207]
    ds_read_b128 v[160:163], v224 offset:49152
    ds_read_b64_tr_b16 v[176:177], v228 offset:49152
    ds_read_b64_tr_b16 v[178:179], v228 offset:49664
    v_mfma_f32_32x32x16_bf16 v[192:207], v[148:151], v[132:135], v[192:207]
    ds_read_b128 v[164:167], v225 offset:49152
    ds_read_b64_tr_b16 v[180:181], v228 offset:51200
    ds_read_b64_tr_b16 v[182:183], v228 offset:51712
    v_mfma_f32_32x32x16_bf16 v[192:207], v[152:155], v[136:139], v[192:207]
    ds_read_b128 v[168:171], v226 offset:49152
    ds_read_b64_tr_b16 v[184:185], v228 offset:53248
    ds_read_b64_tr_b16 v[186:187], v228 offset:53760
    v_mfma_f32_32x32x16_bf16 v[192:207], v[156:159], v[140:143], v[192:207]
    ds_read_b128 v[172:175], v227 offset:49152
    ds_read_b64_tr_b16 v[188:189], v228 offset:55296
    ds_read_b64_tr_b16 v[190:191], v228 offset:55808
    s_waitcnt lgkmcnt(0)
    v_mfma_f32_32x32x16_bf16 v[192:207], v[176:179], v[160:163], v[192:207]
    v_mfma_f32_32x32x16_bf16 v[192:207], v[180:183], v[164:167], v[192:207]
    v_mfma_f32_32x32x16_bf16 v[192:207], v[184:187], v[168:171], v[192:207]
    v_mfma_f32_32x32x16_bf16 v[192:207], v[188:191], v[172:175], v[192:207]
    v_mov_b32 v236, v232
    v_mov_b32 v237, v232
    v_mov_b32 v238, v232
    v_mov_b32 v239, v232
    v_mov_b32 v176, 0
    v_mov_b32 v177, 0
    v_mov_b32 v178, 0
    v_mov_b32 v179, 0
    v_mov_b32 v180, 0
    v_mov_b32 v181, 0
    v_mov_b32 v182, 0
    v_mov_b32 v183, 0
    v_mov_b32 v184, 0
    v_mov_b32 v185, 0
    v_mov_b32 v186, 0
    v_mov_b32 v187, 0
    v_mov_b32 v188, 0
    v_mov_b32 v189, 0
    v_mov_b32 v190, 0
    v_mov_b32 v191, 0
    v_mul_f32 v128, v192, v192
    v_mul_f32 v129, v200, v200
    v_fmac_f32 v128, v193, v193
    v_fmac_f32 v129, v201, v201
    v_fmac_f32 v128, v194, v194
    v_fmac_f32 v129, v202, v202
    v_fmac_f32 v128, v195, v195
    v_fmac_f32 v129, v203, v203
    v_fmac_f32 v128, v196, v196
    v_fmac_f32 v129, v204, v204
    v_fmac_f32 v128, v197, v197
    v_fmac_f32 v129, v205, v205
    v_fmac_f32 v128, v198, v198
    v_fmac_f32 v129, v206, v206
    v_fmac_f32 v128, v199, v199
    v_fmac_f32 v129, v207, v207
    v_cvt_pk_bf16_f32 v136, v192, v193
    v_cvt_pk_bf16_f32 v137, v194, v195
    v_cvt_pk_bf16_f32 v138, v196, v197
    v_cvt_pk_bf16_f32 v139, v198, v199
    v_cvt_pk_bf16_f32 v140, v200, v201
    v_cvt_pk_bf16_f32 v141, v202, v203
    v_cvt_pk_bf16_f32 v142, v204, v205
    v_cvt_pk_bf16_f32 v143, v206, v207
    s_and_b32 s3, s28, 1
    s_lshl_b32 s3, s3, 12
    s_lshr_b32 s34, s28, 1
    s_lshl_b32 s34, s34, 10
    s_add_u32 s3, s3, s34
    s_add_u32 s3, s3, 69632
    v_add_u32 v132, s3, v249
    ds_write_b128 v132, v[136:139]
    ds_write_b128 v132, v[140:143] offset:2048
    v_mov_b32 v130, v128
    v_mov_b32 v131, v128
    s_nop 1
    v_permlane32_swap_b32 v130, v131
    v_add_f32 v128, v130, v131
    v_mov_b32 v130, v129
    v_mov_b32 v131, v129
    s_nop 1
    v_permlane32_swap_b32 v130, v131
    v_add_f32 v129, v130, v131
    v_max_f32 v128, v128, v129
    s_nop 1
    v_max_f32_dpp v128, v128, v128 row_ror:8 row_mask:0xf bank_mask:0xf
    s_nop 1
    v_max_f32_dpp v128, v128, v128 row_ror:4 row_mask:0xf bank_mask:0xf
    s_nop 1
    v_max_f32_dpp v128, v128, v128 row_ror:2 row_mask:0xf bank_mask:0xf
    s_nop 1
    v_max_f32_dpp v128, v128, v128 row_ror:1 row_mask:0xf bank_mask:0xf
    s_nop 1
    v_readlane_b32 s34, v128, 0
    v_readlane_b32 s35, v128, 16
    s_nop 1
    s_max_u32 s34, s34, s35
    s_lshl_b32 s3, s28, 2
    s_add_u32 s3, s3, 77824
    v_mov_b32 v130, s3
    v_mov_b32 v131, s34
    ds_write_b32 v130, v131
    s_waitcnt lgkmcnt(0)
    s_barrier
    v_add_u32 v130, 69632, v249
    v_mov_b32 v131, 77824
    ds_read_b128 v[192:195], v130 offset:0
    ds_read_b128 v[196:199], v130 offset:1024
    ds_read_b128 v[200:203], v130 offset:2048
    ds_read_b128 v[204:207], v130 offset:3072
    ds_read_b128 v[208:211], v130 offset:4096
    ds_read_b128 v[212:215], v130 offset:5120
    ds_read_b128 v[216:219], v130 offset:6144
    ds_read_b128 v[220:223], v130 offset:7168
    ds_read_b128 v[132:135], v131
    s_lshl_b32 s3, s28, 14
    s_add_u32 s34, s3, 65536
    s_add_u32 s40, s26, s34
    s_addc_u32 s41, s27, 0
    s_mov_b32 s42, 16384
    s_mov_b32 s43, 0x00020000
    s_add_u32 s34, s3, 131072
    s_add_u32 s44, s26, s34
    s_addc_u32 s45, s27, 0
    s_mov_b32 s46, 16384
    s_mov_b32 s47, 0x00020000
    s_lshr_b32 s67, s79, 1
    s_lshl_b32 s67, s67, 10
    s_mov_b32 s69, 4096
    s_waitcnt lgkmcnt(0)
    v_max3_f32 v132, v132, v133, v134
    v_max_f32 v132, v132, v135
    s_nop 0
    v_readfirstlane_b32 s66, v132
    s_setprio 2
    s_cmp_lg_u32 s28, 0
    s_cbranch_scc1 L_A_wait
    s_and_b32 s3, s2, 63
    s_lshl_b32 s3, s3, 5
    s_add_u32 s70, s3, 4096
    v_mov_b32 v254, 0
    s_mov_b32 s60, 0
    s_branch L_A_poll1ok
L_A_poll1:
    s_mov_b64 exec, 1
    buffer_load_dwordx4 v[240:243], v254, s[52:55], s70 offen sc1
    s_mov_b64 exec, -1
    s_waitcnt vmcnt(0)
    v_readfirstlane_b32 s34, v240
    v_readfirstlane_b32 s35, v242
    s_nop 0
    s_cmp_eq_u32 s34, s32
    s_cselect_b32 s3, s35, s33
    s_cmp_eq_u32 s3, s32
    s_cbranch_scc1 L_A_poll1ok
    s_add_u32 s60, s60, 1
    s_cmp_lt_u32 s60, 200000
    s_cbranch_scc0 L_A_poll1ok
    s_sleep 0
    s_branch L_A_poll1
L_A_poll1ok:
    v_lshlrev_b32 v254, 5, v251
    s_mov_b32 s60, 0
    buffer_load_dwordx4 v[224:227], v254, s[52:55], s69 offen sc1
    s_sleep 8
L_A_poll:
    buffer_load_dwordx4 v[228:231], v254, s[52:55], s69 offen sc1
    s_waitcnt vmcnt(1)
    v_cmp_eq_u32 vcc, s32, v224
    v_cmp_eq_u32 s[34:35], s32, v226
    s_nop 1
    s_and_b64 vcc, vcc, s[34:35]
    s_cmp_eq_u64 vcc, -1
    s_cbranch_scc1 L_A_pokA
    buffer_load_dwordx4 v[224:227], v254, s[52:55], s69 offen sc1
    s_waitcnt vmcnt(1)
    v_cmp_eq_u32 vcc, s32, v228
    v_cmp_eq_u32 s[34:35], s32, v230
    s_nop 1
    s_and_b64 vcc, vcc, s[34:35]
    s_cmp_eq_u64 vcc, -1
    s_cbranch_scc1 L_A_pokB
    s_add_u32 s60, s60, 1
    s_cmp_lt_u32 s60, 200000
    s_cbranch_scc1 L_A_poll
    s_waitcnt vmcnt(0)
    s_branch L_A_kvto
L_A_pokB:
    v_mov_b32 v241, v229
    v_mov_b32 v243, v231
    s_branch L_A_kvokA
L_A_pokA:
    v_mov_b32 v241, v225
    v_mov_b32 v243, v227
    s_branch L_A_kvokA
L_A_kvto:
    v_mov_b32 v254, 1
    v_mov_b32 v255, 0
    s_mov_b32 s3, 11534272
    buffer_store_dword v254, v255, s[52:55], s3 offen sc1
L_A_kvok:
L_A_kvokA:
    s_setprio 2
    v_mul_f32 v255, s66, v241
    v_cmp_ne_u32 s[34:35], 0, v243
    v_cmp_nge_f32 vcc, 0x44c80000, v255
    s_nop 1
    s_or_b64 vcc, vcc, s[34:35]
    s_cmp_lg_u64 vcc, 0
    s_cselect_b32 s71, 1, 0
    v_mov_b32 v254, 77856
    v_mov_b32 v255, s71
    ds_write_b32 v254, v255
    s_waitcnt lgkmcnt(0)
L_A_wait:
    s_cmp_eq_u32 s28, 0
    s_cbranch_scc1 L_w0_14
    s_waitcnt vmcnt(0)
L_w0_14:
    s_barrier
    s_setprio 2
    v_mov_b32 v254, 77856
    ds_read_b32 v255, v254
    v_mov_b32 v240, v232
    v_mov_b32 v241, v233
    v_mov_b32 v242, v234
    v_mov_b32 v243, v235
    v_mov_b32 v244, v236
    v_mov_b32 v245, v237
    v_mov_b32 v246, v238
    v_mov_b32 v247, v239
    s_waitcnt lgkmcnt(0)
    v_readfirstlane_b32 s3, v255
    s_nop 0
    s_cmp_lg_u32 s3, 0
    s_cbranch_scc1 L_A_fallback
    buffer_load_dwordx4 v[224:227], v249, s[40:43], s67 offen sc1
    s_mov_b64 exec, s[98:99]
    buffer_load_dwordx4 v[232:235], v250, s[44:47], s67 offen sc1
    buffer_load_dwordx4 v[236:239], v250, s[44:47], s67 offen offset:512 sc1
    s_mov_b64 exec, -1
    s_add_u32 s67, s67, 1024
    s_and_b32 s67, s67, 0x3fff
    buffer_load_dwordx4 v[228:231], v249, s[40:43], s67 offen sc1
    v_mov_b32 v252, s32
    v_mov_b32 v253, s33
    s_mov_b64 exec, 1
    buffer_store_dwordx2 v[252:253], off, s[52:55], s62 sc1
    s_mov_b64 exec, -1
    s_waitcnt vmcnt(4)
    v_mfma_f32_32x32x16_bf16 v[128:143], v[224:227], v[192:195], 0
    s_mov_b32 s60, 0
    s_setprio 1
    s_nop 8
    v_and_b32 v255, 31, v251
    s_mul_i32 s3, s28, 17408
    v_lshl_add_u32 v254, v251, 4, s3
    s_add_u32 s3, s3, 2048
    v_lshl_add_u32 v255, v255, 2, s3
L_A_main:
    v_mfma_f32_32x32x16_bf16 v[144:159], v[224:227], v[196:199], 0
    v_exp_f32 v128, v128
    v_exp_f32 v129, v129
    v_exp_f32 v130, v130
    v_exp_f32 v131, v131
    v_exp_f32 v132, v132
    v_smfmac_f32_32x32x32_bf16 v[112:127], v[240:243], v[176:183], v248
    v_exp_f32 v133, v133
    v_exp_f32 v134, v134
    v_exp_f32 v135, v135
    v_exp_f32 v136, v136
    v_exp_f32 v137, v137
    v_smfmac_f32_32x32x32_bf16 v[112:127], v[244:247], v[184:191], v248
    v_exp_f32 v138, v138
    v_exp_f32 v139, v139
    v_exp_f32 v140, v140
    v_exp_f32 v141, v141
    v_exp_f32 v142, v142
    v_exp_f32 v143, v143
    v_mfma_f32_32x32x16_bf16 v[160:175], v[224:227], v[200:203], 0
    v_exp_f32 v144, v144
    v_exp_f32 v145, v145
    v_exp_f32 v146, v146
    v_exp_f32 v147, v147
    v_exp_f32 v148, v148
    s_waitcnt vmcnt(1)
    v_smfmac_f32_32x32x32_bf16 v[0:15], v[232:235], v[128:135], v248
    v_exp_f32 v149, v149
    v_exp_f32 v150, v150
    v_exp_f32 v151, v151
    v_exp_f32 v152, v152
    v_exp_f32 v153, v153
    v_smfmac_f32_32x32x32_bf16 v[0:15], v[236:239], v[136:143], v248
    v_exp_f32 v154, v154
    s_mov_b64 exec, s[98:99]
    buffer_load_dwordx4 v[240:243], v250, s[44:47], s67 offen sc1
    buffer_load_dwordx4 v[244:247], v250, s[44:47], s67 offen offset:512 sc1
    s_mov_b64 exec, -1
    v_exp_f32 v155, v155
    v_exp_f32 v156, v156
    v_exp_f32 v157, v157
    v_exp_f32 v158, v158
    v_exp_f32 v159, v159
    v_mfma_f32_32x32x16_bf16 v[176:191], v[224:227], v[204:207], 0
    v_exp_f32 v160, v160
    v_exp_f32 v161, v161
    v_exp_f32 v162, v162
    v_exp_f32 v163, v163
    v_exp_f32 v164, v164
    v_smfmac_f32_32x32x32_bf16 v[16:31], v[232:235], v[144:151], v248
    v_exp_f32 v165, v165
    v_exp_f32 v166, v166
    v_exp_f32 v167, v167
    v_exp_f32 v168, v168
    v_exp_f32 v169, v169
    v_smfmac_f32_32x32x32_bf16 v[16:31], v[236:239], v[152:159], v248
    v_exp_f32 v170, v170
    v_exp_f32 v171, v171
    v_exp_f32 v172, v172
    v_exp_f32 v173, v173
    v_exp_f32 v174, v174
    v_exp_f32 v175, v175
    v_mfma_f32_32x32x16_bf16 v[128:143], v[224:227], v[208:211], 0
    v_exp_f32 v176, v176
    v_exp_f32 v177, v177
    v_exp_f32 v178, v178
    v_exp_f32 v179, v179
    v_exp_f32 v180, v180
    v_smfmac_f32_32x32x32_bf16 v[32:47], v[232:235], v[160:167], v248
    v_exp_f32 v181, v181
    v_exp_f32 v182, v182
    v_exp_f32 v183, v183
    v_exp_f32 v184, v184
    v_exp_f32 v185, v185
    v_smfmac_f32_32x32x32_bf16 v[32:47], v[236:239], v[168:175], v248
    v_exp_f32 v186, v186
    v_exp_f32 v187, v187
    v_exp_f32 v188, v188
    v_exp_f32 v189, v189
    v_exp_f32 v190, v190
    v_exp_f32 v191, v191
    v_mfma_f32_32x32x16_bf16 v[144:159], v[224:227], v[212:215], 0
    v_exp_f32 v128, v128
    v_exp_f32 v129, v129
    v_exp_f32 v130, v130
    v_exp_f32 v131, v131
    v_exp_f32 v132, v132
    v_smfmac_f32_32x32x32_bf16 v[48:63], v[232:235], v[176:183], v248
    v_exp_f32 v133, v133
    v_exp_f32 v134, v134
    v_exp_f32 v135, v135
    v_exp_f32 v136, v136
    v_exp_f32 v137, v137
    v_smfmac_f32_32x32x32_bf16 v[48:63], v[236:239], v[184:191], v248
    v_exp_f32 v138, v138
    v_exp_f32 v139, v139
    v_exp_f32 v140, v140
    v_exp_f32 v141, v141
    v_exp_f32 v142, v142
    v_exp_f32 v143, v143
    v_mfma_f32_32x32x16_bf16 v[160:175], v[224:227], v[216:219], 0
    v_exp_f32 v144, v144
    v_exp_f32 v145, v145
    v_exp_f32 v146, v146
    v_exp_f32 v147, v147
    v_exp_f32 v148, v148
    v_smfmac_f32_32x32x32_bf16 v[64:79], v[232:235], v[128:135], v248
    v_exp_f32 v149, v149
    v_exp_f32 v150, v150
    v_exp_f32 v151, v151
    v_exp_f32 v152, v152
    v_exp_f32 v153, v153
    v_smfmac_f32_32x32x32_bf16 v[64:79], v[236:239], v[136:143], v248
    v_exp_f32 v154, v154
    v_exp_f32 v155, v155
    v_exp_f32 v156, v156
    v_exp_f32 v157, v157
    v_exp_f32 v158, v158
    v_exp_f32 v159, v159
    v_mfma_f32_32x32x16_bf16 v[176:191], v[224:227], v[220:223], 0
    v_exp_f32 v160, v160
    v_exp_f32 v161, v161
    v_exp_f32 v162, v162
    v_exp_f32 v163, v163
    v_exp_f32 v164, v164
    v_smfmac_f32_32x32x32_bf16 v[80:95], v[232:235], v[144:151], v248
    v_exp_f32 v165, v165
    v_exp_f32 v166, v166
    v_exp_f32 v167, v167
    v_exp_f32 v168, v168
    v_exp_f32 v169, v169
    v_smfmac_f32_32x32x32_bf16 v[80:95], v[236:239], v[152:159], v248
    v_exp_f32 v170, v170
    v_exp_f32 v171, v171
    v_exp_f32 v172, v172
    v_exp_f32 v173, v173
    v_exp_f32 v174, v174
    v_exp_f32 v175, v175
    s_waitcnt vmcnt(2)
    v_mfma_f32_32x32x16_bf16 v[128:143], v[228:231], v[192:195], 0
    v_exp_f32 v176, v176
    v_exp_f32 v177, v177
    v_exp_f32 v178, v178
    v_exp_f32 v179, v179
    v_exp_f32 v180, v180
    v_smfmac_f32_32x32x32_bf16 v[96:111], v[232:235], v[160:167], v248
    v_exp_f32 v181, v181
    v_exp_f32 v182, v182
    v_exp_f32 v183, v183
    v_exp_f32 v184, v184
    v_exp_f32 v185, v185
    v_smfmac_f32_32x32x32_bf16 v[96:111], v[236:239], v[168:175], v248
    v_exp_f32 v186, v186
    s_add_u32 s67, s67, 1024
    s_and_b32 s67, s67, 0x3fff
    buffer_load_dwordx4 v[224:227], v249, s[40:43], s67 offen sc1
    v_exp_f32 v187, v187
    v_exp_f32 v188, v188
    v_exp_f32 v189, v189
    v_exp_f32 v190, v190
    v_exp_f32 v191, v191
    v_mfma_f32_32x32x16_bf16 v[144:159], v[228:231], v[196:199], 0
    v_exp_f32 v128, v128
    v_exp_f32 v129, v129
    v_exp_f32 v130, v130
    v_exp_f32 v131, v131
    v_exp_f32 v132, v132
    v_smfmac_f32_32x32x32_bf16 v[112:127], v[232:235], v[176:183], v248
    v_exp_f32 v133, v133
    v_exp_f32 v134, v134
    v_exp_f32 v135, v135
    v_exp_f32 v136, v136
    v_exp_f32 v137, v137
    v_smfmac_f32_32x32x32_bf16 v[112:127], v[236:239], v[184:191], v248
    v_exp_f32 v138, v138
    v_exp_f32 v139, v139
    v_exp_f32 v140, v140
    v_exp_f32 v141, v141
    v_exp_f32 v142, v142
    v_exp_f32 v143, v143
    v_mfma_f32_32x32x16_bf16 v[160:175], v[228:231], v[200:203], 0
    v_exp_f32 v144, v144
    v_exp_f32 v145, v145
    v_exp_f32 v146, v146
    v_exp_f32 v147, v147
    v_exp_f32 v148, v148
    s_waitcnt vmcnt(1)
    v_smfmac_f32_32x32x32_bf16 v[0:15], v[240:243], v[128:135], v248
    v_exp_f32 v149, v149
    v_exp_f32 v150, v150
    v_exp_f32 v151, v151
    v_exp_f32 v152, v152
    v_exp_f32 v153, v153
    v_smfmac_f32_32x32x32_bf16 v[0:15], v[244:247], v[136:143], v248
    v_exp_f32 v154, v154
    s_mov_b64 exec, s[98:99]
    buffer_load_dwordx4 v[232:235], v250, s[44:47], s67 offen sc1
    buffer_load_dwordx4 v[236:239], v250, s[44:47], s67 offen offset:512 sc1
    s_mov_b64 exec, -1
    v_exp_f32 v155, v155
    v_exp_f32 v156, v156
    v_exp_f32 v157, v157
    v_exp_f32 v158, v158
    v_exp_f32 v159, v159
    v_mfma_f32_32x32x16_bf16 v[176:191], v[228:231], v[204:207], 0
    v_exp_f32 v160, v160
    v_exp_f32 v161, v161
    v_exp_f32 v162, v162
    v_exp_f32 v163, v163
    v_exp_f32 v164, v164
    v_smfmac_f32_32x32x32_bf16 v[16:31], v[240:243], v[144:151], v248
    v_exp_f32 v165, v165
    v_exp_f32 v166, v166
    v_exp_f32 v167, v167
    v_exp_f32 v168, v168
    v_exp_f32 v169, v169
    v_smfmac_f32_32x32x32_bf16 v[16:31], v[244:247], v[152:159], v248
    v_exp_f32 v170, v170
    v_exp_f32 v171, v171
    v_exp_f32 v172, v172
    v_exp_f32 v173, v173
    v_exp_f32 v174, v174
    v_exp_f32 v175, v175
    v_mfma_f32_32x32x16_bf16 v[128:143], v[228:231], v[208:211], 0
    v_exp_f32 v176, v176
    v_exp_f32 v177, v177
    v_exp_f32 v178, v178
    v_exp_f32 v179, v179
    v_exp_f32 v180, v180
    v_smfmac_f32_32x32x32_bf16 v[32:47], v[240:243], v[160:167], v248
    v_exp_f32 v181, v181
    v_exp_f32 v182, v182
    v_exp_f32 v183, v183
    v_exp_f32 v184, v184
    v_exp_f32 v185, v185
    v_smfmac_f32_32x32x32_bf16 v[32:47], v[244:247], v[168:175], v248
    v_exp_f32 v186, v186
    v_exp_f32 v187, v187
    v_exp_f32 v188, v188
    v_exp_f32 v189, v189
    v_exp_f32 v190, v190
    v_exp_f32 v191, v191
    v_mfma_f32_32x32x16_bf16 v[144:159], v[228:231], v[212:215], 0
    v_exp_f32 v128, v128
    v_exp_f32 v129, v129
    v_exp_f32 v130, v130
    v_exp_f32 v131, v131
    v_exp_f32 v132, v132
    v_smfmac_f32_32x32x32_bf16 v[48:63], v[240:243], v[176:183], v248
    v_exp_f32 v133, v133
    v_exp_f32 v134, v134
    v_exp_f32 v135, v135
    v_exp_f32 v136, v136
    v_exp_f32 v137, v137
    v_smfmac_f32_32x32x32_bf16 v[48:63], v[244:247], v[184:191], v248
    v_exp_f32 v138, v138
    v_exp_f32 v139, v139
    v_exp_f32 v140, v140
    v_exp_f32 v141, v141
    v_exp_f32 v142, v142
    v_exp_f32 v143, v143
    v_mfma_f32_32x32x16_bf16 v[160:175], v[228:231], v[216:219], 0
    v_exp_f32 v144, v144
    v_exp_f32 v145, v145
    v_exp_f32 v146, v146
    v_exp_f32 v147, v147
    v_exp_f32 v148, v148
    v_smfmac_f32_32x32x32_bf16 v[64:79], v[240:243], v[128:135], v248
    v_exp_f32 v149, v149
    v_exp_f32 v150, v150
    v_exp_f32 v151, v151
    v_exp_f32 v152, v152
    v_exp_f32 v153, v153
    v_smfmac_f32_32x32x32_bf16 v[64:79], v[244:247], v[136:143], v248
    v_exp_f32 v154, v154
    v_exp_f32 v155, v155
    v_exp_f32 v156, v156
    v_exp_f32 v157, v157
    v_exp_f32 v158, v158
    v_exp_f32 v159, v159
    v_mfma_f32_32x32x16_bf16 v[176:191], v[228:231], v[220:223], 0
    v_exp_f32 v160, v160
    v_exp_f32 v161, v161
    v_exp_f32 v162, v162
    v_exp_f32 v163, v163
    v_exp_f32 v164, v164
    v_smfmac_f32_32x32x32_bf16 v[80:95], v[240:243], v[144:151], v248
    v_exp_f32 v165, v165
    v_exp_f32 v166, v166
    v_exp_f32 v167, v167
    v_exp_f32 v168, v168
    v_exp_f32 v169, v169
    v_smfmac_f32_32x32x32_bf16 v[80:95], v[244:247], v[152:159], v248
    v_exp_f32 v170, v170
    v_exp_f32 v171, v171
    v_exp_f32 v172, v172
    v_exp_f32 v173, v173
    v_exp_f32 v174, v174
    v_exp_f32 v175, v175
    s_waitcnt vmcnt(2)
    v_mfma_f32_32x32x16_bf16 v[128:143], v[224:227], v[192:195], 0
    v_exp_f32 v176, v176
    v_exp_f32 v177, v177
    v_exp_f32 v178, v178
    v_exp_f32 v179, v179
    v_exp_f32 v180, v180
    v_smfmac_f32_32x32x32_bf16 v[96:111], v[240:243], v[160:167], v248
    v_exp_f32 v181, v181
    v_exp_f32 v182, v182
    v_exp_f32 v183, v183
    v_exp_f32 v184, v184
    v_exp_f32 v185, v185
    v_smfmac_f32_32x32x32_bf16 v[96:111], v[244:247], v[168:175], v248
    v_exp_f32 v186, v186
    s_add_u32 s67, s67, 1024
    s_and_b32 s67, s67, 0x3fff
    buffer_load_dwordx4 v[228:231], v249, s[40:43], s67 offen sc1
    v_exp_f32 v187, v187
    v_exp_f32 v188, v188
    v_exp_f32 v189, v189
    v_exp_f32 v190, v190
    v_exp_f32 v191, v191
    s_add_u32 s60, s60, 1
    s_cmp_lt_u32 s60, 7
    s_cbranch_scc1 L_A_main
    v_mfma_f32_32x32x16_bf16 v[144:159], v[224:227], v[196:199], 0
    v_exp_f32 v128, v128
    v_exp_f32 v129, v129
    v_exp_f32 v130, v130
    v_exp_f32 v131, v131
    v_exp_f32 v132, v132
    v_smfmac_f32_32x32x32_bf16 v[112:127], v[240:243], v[176:183], v248
    v_exp_f32 v133, v133
    v_exp_f32 v134, v134
    v_exp_f32 v135, v135
    v_exp_f32 v136, v136
    v_exp_f32 v137, v137
    v_smfmac_f32_32x32x32_bf16 v[112:127], v[244:247], v[184:191], v248
    v_exp_f32 v138, v138
    v_exp_f32 v139, v139
    v_exp_f32 v140, v140
    v_exp_f32 v141, v141
    v_exp_f32 v142, v142
    v_exp_f32 v143, v143
    v_mfma_f32_32x32x16_bf16 v[160:175], v[224:227], v[200:203], 0
    v_exp_f32 v144, v144
    v_exp_f32 v145, v145
    v_exp_f32 v146, v146
    v_exp_f32 v147, v147
    v_exp_f32 v148, v148
    s_waitcnt vmcnt(1)
    v_smfmac_f32_32x32x32_bf16 v[0:15], v[232:235], v[128:135], v248
    v_exp_f32 v149, v149
    v_exp_f32 v150, v150
    v_exp_f32 v151, v151
    v_exp_f32 v152, v152
    v_exp_f32 v153, v153
    v_smfmac_f32_32x32x32_bf16 v[0:15], v[236:239], v[136:143], v248
    v_exp_f32 v154, v154
    s_mov_b64 exec, s[98:99]
    buffer_load_dwordx4 v[240:243], v250, s[44:47], s67 offen sc1
    buffer_load_dwordx4 v[244:247], v250, s[44:47], s67 offen offset:512 sc1
    s_mov_b64 exec, -1
    v_exp_f32 v155, v155
    v_exp_f32 v156, v156
    v_exp_f32 v157, v157
    v_exp_f32 v158, v158
    v_exp_f32 v159, v159
    v_mfma_f32_32x32x16_bf16 v[176:191], v[224:227], v[204:207], 0
    v_exp_f32 v160, v160
    v_exp_f32 v161, v161
    v_exp_f32 v162, v162
    v_exp_f32 v163, v163
    v_exp_f32 v164, v164
    v_smfmac_f32_32x32x32_bf16 v[16:31], v[232:235], v[144:151], v248
    v_exp_f32 v165, v165
    v_exp_f32 v166, v166
    v_exp_f32 v167, v167
    v_exp_f32 v168, v168
    v_exp_f32 v169, v169
    v_smfmac_f32_32x32x32_bf16 v[16:31], v[236:239], v[152:159], v248
    v_exp_f32 v170, v170
    v_exp_f32 v171, v171
    v_exp_f32 v172, v172
    v_exp_f32 v173, v173
    v_exp_f32 v174, v174
    v_exp_f32 v175, v175
    v_mfma_f32_32x32x16_bf16 v[128:143], v[224:227], v[208:211], 0
    v_exp_f32 v176, v176
    v_exp_f32 v177, v177
    v_exp_f32 v178, v178
    v_exp_f32 v179, v179
    v_exp_f32 v180, v180
    v_smfmac_f32_32x32x32_bf16 v[32:47], v[232:235], v[160:167], v248
    v_exp_f32 v181, v181
    v_exp_f32 v182, v182
    v_exp_f32 v183, v183
    v_exp_f32 v184, v184
    v_exp_f32 v185, v185
    v_smfmac_f32_32x32x32_bf16 v[32:47], v[236:239], v[168:175], v248
    v_exp_f32 v186, v186
    v_exp_f32 v187, v187
    v_exp_f32 v188, v188
    v_exp_f32 v189, v189
    v_exp_f32 v190, v190
    v_exp_f32 v191, v191
    v_mfma_f32_32x32x16_bf16 v[144:159], v[224:227], v[212:215], 0
    v_exp_f32 v128, v128
    v_exp_f32 v129, v129
    v_exp_f32 v130, v130
    v_exp_f32 v131, v131
    v_exp_f32 v132, v132
    v_smfmac_f32_32x32x32_bf16 v[48:63], v[232:235], v[176:183], v248
    v_exp_f32 v133, v133
    v_exp_f32 v134, v134
    v_exp_f32 v135, v135
    v_exp_f32 v136, v136
    v_exp_f32 v137, v137
    v_smfmac_f32_32x32x32_bf16 v[48:63], v[236:239], v[184:191], v248
    v_exp_f32 v138, v138
    v_exp_f32 v139, v139
    v_exp_f32 v140, v140
    v_exp_f32 v141, v141
    v_exp_f32 v142, v142
    v_exp_f32 v143, v143
    v_mfma_f32_32x32x16_bf16 v[160:175], v[224:227], v[216:219], 0
    v_exp_f32 v144, v144
    v_exp_f32 v145, v145
    v_exp_f32 v146, v146
    v_exp_f32 v147, v147
    v_exp_f32 v148, v148
    v_smfmac_f32_32x32x32_bf16 v[64:79], v[232:235], v[128:135], v248
    v_exp_f32 v149, v149
    v_exp_f32 v150, v150
    v_exp_f32 v151, v151
    v_exp_f32 v152, v152
    v_exp_f32 v153, v153
    v_smfmac_f32_32x32x32_bf16 v[64:79], v[236:239], v[136:143], v248
    v_exp_f32 v154, v154
    v_exp_f32 v155, v155
    v_exp_f32 v156, v156
    v_exp_f32 v157, v157
    v_exp_f32 v158, v158
    v_exp_f32 v159, v159
    v_mfma_f32_32x32x16_bf16 v[176:191], v[224:227], v[220:223], 0
    v_exp_f32 v160, v160
    v_exp_f32 v161, v161
    v_exp_f32 v162, v162
    v_exp_f32 v163, v163
    v_exp_f32 v164, v164
    v_smfmac_f32_32x32x32_bf16 v[80:95], v[232:235], v[144:151], v248
    v_exp_f32 v165, v165
    v_exp_f32 v166, v166
    v_exp_f32 v167, v167
    v_exp_f32 v168, v168
    v_exp_f32 v169, v169
    v_smfmac_f32_32x32x32_bf16 v[80:95], v[236:239], v[152:159], v248
    v_exp_f32 v170, v170
    v_exp_f32 v171, v171
    v_exp_f32 v172, v172
    v_exp_f32 v173, v173
    v_exp_f32 v174, v174
    v_exp_f32 v175, v175
    s_waitcnt vmcnt(2)
    v_mfma_f32_32x32x16_bf16 v[128:143], v[228:231], v[192:195], 0
    v_exp_f32 v176, v176
    v_exp_f32 v177, v177
    v_exp_f32 v178, v178
    v_exp_f32 v179, v179
    v_exp_f32 v180, v180
    v_smfmac_f32_32x32x32_bf16 v[96:111], v[232:235], v[160:167], v248
    v_exp_f32 v181, v181
    v_exp_f32 v182, v182
    v_exp_f32 v183, v183
    v_exp_f32 v184, v184
    v_exp_f32 v185, v185
    v_smfmac_f32_32x32x32_bf16 v[96:111], v[236:239], v[168:175], v248
    v_exp_f32 v186, v186
    v_exp_f32 v187, v187
    v_exp_f32 v188, v188
    v_exp_f32 v189, v189
    v_exp_f32 v190, v190
    v_exp_f32 v191, v191
    v_mfma_f32_32x32x16_bf16 v[144:159], v[228:231], v[196:199], 0
    v_exp_f32 v128, v128
    v_exp_f32 v129, v129
    v_exp_f32 v130, v130
    v_exp_f32 v131, v131
    v_exp_f32 v132, v132
    v_smfmac_f32_32x32x32_bf16 v[112:127], v[232:235], v[176:183], v248
    v_exp_f32 v133, v133
    v_exp_f32 v134, v134
    v_exp_f32 v135, v135
    v_exp_f32 v136, v136
    v_exp_f32 v137, v137
    v_smfmac_f32_32x32x32_bf16 v[112:127], v[236:239], v[184:191], v248
    v_exp_f32 v138, v138
    v_exp_f32 v139, v139
    v_exp_f32 v140, v140
    v_exp_f32 v141, v141
    v_exp_f32 v142, v142
    v_exp_f32 v143, v143
    v_mfma_f32_32x32x16_bf16 v[160:175], v[228:231], v[200:203], 0
    v_exp_f32 v144, v144
    v_exp_f32 v145, v145
    v_exp_f32 v146, v146
    v_exp_f32 v147, v147
    v_exp_f32 v148, v148
    s_waitcnt vmcnt(0)
    v_smfmac_f32_32x32x32_bf16 v[0:15], v[240:243], v[128:135], v248
    v_exp_f32 v149, v149
    v_exp_f32 v150, v150
    v_exp_f32 v151, v151
    v_exp_f32 v152, v152
    v_exp_f32 v153, v153
    v_smfmac_f32_32x32x32_bf16 v[0:15], v[244:247], v[136:143], v248
    v_exp_f32 v154, v154
    v_exp_f32 v155, v155
    v_exp_f32 v156, v156
    v_exp_f32 v157, v157
    v_exp_f32 v158, v158
    v_exp_f32 v159, v159
    v_mfma_f32_32x32x16_bf16 v[176:191], v[228:231], v[204:207], 0
    v_exp_f32 v160, v160
    v_exp_f32 v161, v161
    v_exp_f32 v162, v162
    v_exp_f32 v163, v163
    v_exp_f32 v164, v164
    v_smfmac_f32_32x32x32_bf16 v[16:31], v[240:243], v[144:151], v248
    v_exp_f32 v165, v165
    v_exp_f32 v166, v166
    v_exp_f32 v167, v167
    v_exp_f32 v168, v168
    v_exp_f32 v169, v169
    v_smfmac_f32_32x32x32_bf16 v[16:31], v[244:247], v[152:159], v248
    v_exp_f32 v170, v170
    v_exp_f32 v171, v171
    v_exp_f32 v172, v172
    v_exp_f32 v173, v173
    v_exp_f32 v174, v174
    v_exp_f32 v175, v175
    ds_write_b128 v254, v[0:3] offset:0
    ds_write_b128 v254, v[4:7] offset:1024
    v_mfma_f32_32x32x16_bf16 v[128:143], v[228:231], v[208:211], 0
    v_exp_f32 v176, v176
    v_exp_f32 v177, v177
    v_exp_f32 v178, v178
    v_exp_f32 v179, v179
    v_exp_f32 v180, v180
    v_smfmac_f32_32x32x32_bf16 v[32:47], v[240:243], v[160:167], v248
    v_exp_f32 v181, v181
    v_exp_f32 v182, v182
    v_exp_f32 v183, v183
    v_exp_f32 v184, v184
    v_exp_f32 v185, v185
    v_smfmac_f32_32x32x32_bf16 v[32:47], v[244:247], v[168:175], v248
    v_exp_f32 v186, v186
    v_exp_f32 v187, v187
    v_exp_f32 v188, v188
    v_exp_f32 v189, v189
    v_exp_f32 v190, v190
    v_exp_f32 v191, v191
    ds_write_b128 v254, v[16:19] offset:2176
    ds_write_b128 v254, v[20:23] offset:3200
    v_mfma_f32_32x32x16_bf16 v[144:159], v[228:231], v[212:215], 0
    v_exp_f32 v128, v128
    v_exp_f32 v129, v129
    v_exp_f32 v130, v130
    v_exp_f32 v131, v131
    v_exp_f32 v132, v132
    v_smfmac_f32_32x32x32_bf16 v[48:63], v[240:243], v[176:183], v248
    v_exp_f32 v133, v133
    v_exp_f32 v134, v134
    v_exp_f32 v135, v135
    v_exp_f32 v136, v136
    v_exp_f32 v137, v137
    v_smfmac_f32_32x32x32_bf16 v[48:63], v[244:247], v[184:191], v248
    v_exp_f32 v138, v138
    v_exp_f32 v139, v139
    v_exp_f32 v140, v140
    v_exp_f32 v141, v141
    v_exp_f32 v142, v142
    v_exp_f32 v143, v143
    ds_write_b128 v254, v[32:35] offset:4352
    ds_write_b128 v254, v[36:39] offset:5376
    v_mfma_f32_32x32x16_bf16 v[160:175], v[228:231], v[216:219], 0
    v_exp_f32 v144, v144
    v_exp_f32 v145, v145
    v_exp_f32 v146, v146
    v_exp_f32 v147, v147
    v_exp_f32 v148, v148
    v_smfmac_f32_32x32x32_bf16 v[64:79], v[240:243], v[128:135], v248
    v_exp_f32 v149, v149
    v_exp_f32 v150, v150
    v_exp_f32 v151, v151
    v_exp_f32 v152, v152
    v_exp_f32 v153, v153
    v_smfmac_f32_32x32x32_bf16 v[64:79], v[244:247], v[136:143], v248
    v_exp_f32 v154, v154
    v_exp_f32 v155, v155
    v_exp_f32 v156, v156
    v_exp_f32 v157, v157
    v_exp_f32 v158, v158
    v_exp_f32 v159, v159
    ds_write_b128 v254, v[48:51] offset:6528
    ds_write_b128 v254, v[52:55] offset:7552
    v_mfma_f32_32x32x16_bf16 v[176:191], v[228:231], v[220:223], 0
    v_exp_f32 v160, v160
    v_exp_f32 v161, v161
    v_exp_f32 v162, v162
    v_exp_f32 v163, v163
    v_exp_f32 v164, v164
    v_smfmac_f32_32x32x32_bf16 v[80:95], v[240:243], v[144:151], v248
    v_exp_f32 v165, v165
    v_exp_f32 v166, v166
    v_exp_f32 v167, v167
    v_exp_f32 v168, v168
    v_exp_f32 v169, v169
    v_smfmac_f32_32x32x32_bf16 v[80:95], v[244:247], v[152:159], v248
    v_exp_f32 v170, v170
    v_exp_f32 v171, v171
    v_exp_f32 v172, v172
    v_exp_f32 v173, v173
    v_exp_f32 v174, v174
    v_exp_f32 v175, v175
    ds_write_b128 v254, v[64:67] offset:8704
    ds_write_b128 v254, v[68:71] offset:9728
    v_exp_f32 v176, v176
    v_exp_f32 v177, v177
    v_exp_f32 v178, v178
    v_exp_f32 v179, v179
    v_exp_f32 v180, v180
    v_smfmac_f32_32x32x32_bf16 v[96:111], v[240:243], v[160:167], v248
    v_exp_f32 v181, v181
    v_exp_f32 v182, v182
    v_exp_f32 v183, v183
    v_exp_f32 v184, v184
    v_exp_f32 v185, v185
    v_smfmac_f32_32x32x32_bf16 v[96:111], v[244:247], v[168:175], v248
    v_exp_f32 v186, v186
    v_exp_f32 v187, v187
    v_exp_f32 v188, v188
    v_exp_f32 v189, v189
    v_exp_f32 v190, v190
    v_exp_f32 v191, v191
    ds_write_b128 v254, v[80:83] offset:10880
    ds_write_b128 v254, v[84:87] offset:11904
    s_nop 1
    v_smfmac_f32_32x32x32_bf16 v[112:127], v[240:243], v[176:183], v248
    v_smfmac_f32_32x32x32_bf16 v[112:127], v[244:247], v[184:191], v248
    s_setprio 2
    s_mov_b32 exec_hi, 0
    ds_write_b32 v255, v8 offset:0
    ds_write_b32 v255, v24 offset:2176
    ds_write_b32 v255, v40 offset:4352
    ds_write_b32 v255, v56 offset:6528
    ds_write_b32 v255, v72 offset:8704
    ds_write_b32 v255, v88 offset:10880
    ds_write_b32 v255, v104 offset:13056
    s_mov_b32 exec_hi, -1
    ds_write_b128 v254, v[96:99] offset:13056
    ds_write_b128 v254, v[100:103] offset:14080
    s_nop 3
    ds_write_b128 v254, v[112:115] offset:15232
    ds_write_b128 v254, v[116:119] offset:16256
    s_mov_b32 exec_hi, 0
    ds_write_b32 v255, v120 offset:15232
    s_mov_b32 exec_hi, -1
L_A_reduce:
    v_mov_b32 v128, v251
    v_and_b32 v129, 31, v128
    s_mul_i32 s3, s28, 4352
    v_lshl_add_u32 v130, v128, 4, s3
    s_add_u32 s3, s3, 2048
    v_lshl_add_u32 v131, v129, 2, s3
    s_waitcnt lgkmcnt(0)
    s_barrier
    ds_read_b128 v[0:3], v130 offset:0
    ds_read_b128 v[4:7], v130 offset:1024
    ds_read_b32 v8, v131 offset:0
    ds_read_b128 v[12:15], v130 offset:17408
    ds_read_b128 v[16:19], v130 offset:18432
    ds_read_b32 v20, v131 offset:17408
    ds_read_b128 v[24:27], v130 offset:34816
    ds_read_b128 v[28:31], v130 offset:35840
    ds_read_b32 v32, v131 offset:34816
    ds_read_b128 v[36:39], v130 offset:52224
    ds_read_b128 v[40:43], v130 offset:53248
    ds_read_b32 v44, v131 offset:52224
    ds_read_b128 v[48:51], v130 offset:2176
    ds_read_b128 v[52:55], v130 offset:3200
    ds_read_b32 v56, v131 offset:2176
    ds_read_b128 v[60:63], v130 offset:19584
    ds_read_b128 v[64:67], v130 offset:20608
    ds_read_b32 v68, v131 offset:19584
    ds_read_b128 v[72:75], v130 offset:36992
    ds_read_b128 v[76:79], v130 offset:38016
    ds_read_b32 v80, v131 offset:36992
    ds_read_b128 v[84:87], v130 offset:54400
    ds_read_b128 v[88:91], v130 offset:55424
    ds_read_b32 v92, v131 offset:54400
    v_lshlrev_b32 v132, 4, v128
    s_lshl_b32 s3, s29, 6
    s_lshl_b32 s34, s30, 2
    s_add_u32 s34, s34, s28
    s_add_u32 s3, s3, s34
    s_lshl_b32 s3, s3, 10
    s_add_u32 s61, s3, 262144
    s_waitcnt lgkmcnt(12)
    v_add_f32 v0, v0, v12
    v_add_f32 v24, v24, v36
    v_add_f32 v1, v1, v13
    v_add_f32 v25, v25, v37
    v_add_f32 v2, v2, v14
    v_add_f32 v26, v26, v38
    v_add_f32 v3, v3, v15
    v_add_f32 v27, v27, v39
    v_add_f32 v4, v4, v16
    v_add_f32 v28, v28, v40
    v_add_f32 v5, v5, v17
    v_add_f32 v29, v29, v41
    v_add_f32 v6, v6, v18
    v_add_f32 v30, v30, v42
    v_add_f32 v7, v7, v19
    v_add_f32 v31, v31, v43
    v_add_f32 v8, v8, v20
    v_add_f32 v32, v32, v44
    v_add_f32 v0, v0, v24
    v_add_f32 v1, v1, v25
    v_add_f32 v2, v2, v26
    v_add_f32 v3, v3, v27
    v_add_f32 v4, v4, v28
    v_add_f32 v5, v5, v29
    v_add_f32 v6, v6, v30
    v_add_f32 v7, v7, v31
    v_add_f32 v8, v8, v32
    v_rcp_f32 v8, v8
    s_nop 0
    v_mul_f32 v0, v0, v8
    v_mul_f32 v1, v1, v8
    v_mul_f32 v2, v2, v8
    v_mul_f32 v3, v3, v8
    v_mul_f32 v4, v4, v8
    v_mul_f32 v5, v5, v8
    v_mul_f32 v6, v6, v8
    v_mul_f32 v7, v7, v8
    v_cvt_pk_bf16_f32 v12, v0, v1
    v_cvt_pk_bf16_f32 v13, v2, v3
    v_cvt_pk_bf16_f32 v14, v4, v5
    v_cvt_pk_bf16_f32 v15, v6, v7
    s_add_u32 s3, s61, 0
    buffer_store_dwordx4 v[12:15], v132, s[52:55], s3 offen sc1
    s_waitcnt lgkmcnt(0)
    v_add_f32 v48, v48, v60
    v_add_f32 v72, v72, v84
    v_add_f32 v49, v49, v61
    v_add_f32 v73, v73, v85
    v_add_f32 v50, v50, v62
    v_add_f32 v74, v74, v86
    v_add_f32 v51, v51, v63
    v_add_f32 v75, v75, v87
    v_add_f32 v52, v52, v64
    v_add_f32 v76, v76, v88
    v_add_f32 v53, v53, v65
    v_add_f32 v77, v77, v89
    v_add_f32 v54, v54, v66
    v_add_f32 v78, v78, v90
    v_add_f32 v55, v55, v67
    v_add_f32 v79, v79, v91
    v_add_f32 v56, v56, v68
    v_add_f32 v80, v80, v92
    v_add_f32 v48, v48, v72
    v_add_f32 v49, v49, v73
    v_add_f32 v50, v50, v74
    v_add_f32 v51, v51, v75
    v_add_f32 v52, v52, v76
    v_add_f32 v53, v53, v77
    v_add_f32 v54, v54, v78
    v_add_f32 v55, v55, v79
    v_add_f32 v56, v56, v80
    v_rcp_f32 v56, v56
    s_nop 0
    v_mul_f32 v48, v48, v56
    v_mul_f32 v49, v49, v56
    v_mul_f32 v50, v50, v56
    v_mul_f32 v51, v51, v56
    v_mul_f32 v52, v52, v56
    v_mul_f32 v53, v53, v56
    v_mul_f32 v54, v54, v56
    v_mul_f32 v55, v55, v56
    v_cvt_pk_bf16_f32 v60, v48, v49
    v_cvt_pk_bf16_f32 v61, v50, v51
    v_cvt_pk_bf16_f32 v62, v52, v53
    v_cvt_pk_bf16_f32 v63, v54, v55
    s_add_u32 s3, s61, 32768
    buffer_store_dwordx4 v[60:63], v132, s[52:55], s3 offen sc1
    s_endpgm
L_A_fallback:
    v_mov_b32 v252, s32
    v_mov_b32 v253, s33
    s_mov_b64 exec, 1
    buffer_store_dwordx2 v[252:253], off, s[52:55], s62 sc1
    s_mov_b64 exec, -1
    v_mbcnt_lo_u32_b32 v70, -1, 0
    v_mbcnt_hi_u32_b32 v70, -1, v70
    v_and_b32 v71, 31, v70
    v_lshlrev_b32 v72, 4, v70
    v_add_u32 v72, 69632, v72
    s_mul_i32 s3, s28, 17408
    v_lshl_add_u32 v73, v70, 4, s3
    s_add_u32 s3, s3, 2048
    v_lshl_add_u32 v74, v71, 2, s3
    s_lshl_b32 s3, s28, 7
    s_add_u32 s3, s3, 78080
    v_lshl_add_u32 v75, v71, 2, s3
    v_lshlrev_b32 v76, 2, v71
    v_add_u32 v76, 78080, v76
    s_mov_b32 s61, 0
L_F_tile:
    ds_read_b128 v[0:3], v72
    v_mov_b32 v64, 0xff7fffff
    s_mov_b32 s67, 0
L_F_p1:
    buffer_load_dwordx4 v[4:7], v249, s[40:43], s67 offen sc1
    s_waitcnt vmcnt(0) lgkmcnt(0)
    v_mfma_f32_32x32x16_bf16 v[16:31], v[4:7], v[0:3], 0
    s_nop 15
    v_max3_f32 v64, v64, v16, v17
    v_max3_f32 v64, v64, v18, v19
    v_max3_f32 v64, v64, v20, v21
    v_max3_f32 v64, v64, v22, v23
    v_max3_f32 v64, v64, v24, v25
    v_max3_f32 v64, v64, v26, v27
    v_max3_f32 v64, v64, v28, v29
    v_max3_f32 v64, v64, v30, v31
    s_add_u32 s67, s67, 1024
    s_cmp_lt_u32 s67, 16384
    s_cbranch_scc1 L_F_p1
    v_mov_b32 v65, v64
    v_mov_b32 v66, v64
    s_nop 1
    v_permlane32_swap_b32 v65, v66
    v_max_f32 v64, v65, v66
    ds_write_b32 v75, v64
    s_waitcnt lgkmcnt(0)
    s_barrier
    ds_read_b32 v64, v76
    ds_read_b32 v65, v76 offset:128
    ds_read_b32 v66, v76 offset:256
    ds_read_b32 v67, v76 offset:384
    s_waitcnt lgkmcnt(0)
    v_max3_f32 v64, v64, v65, v66
    v_max_f32 v64, v64, v67
    s_barrier
    v_sub_f32 v32, 0, v64
    v_mov_b32 v48, 0
    v_sub_f32 v33, 0, v64
    v_mov_b32 v49, 0
    v_sub_f32 v34, 0, v64
    v_mov_b32 v50, 0
    v_sub_f32 v35, 0, v64
    v_mov_b32 v51, 0
    v_sub_f32 v36, 0, v64
    v_mov_b32 v52, 0
    v_sub_f32 v37, 0, v64
    v_mov_b32 v53, 0
    v_sub_f32 v38, 0, v64
    v_mov_b32 v54, 0
    v_sub_f32 v39, 0, v64
    v_mov_b32 v55, 0
    v_sub_f32 v40, 0, v64
    v_mov_b32 v56, 0
    v_sub_f32 v41, 0, v64
    v_mov_b32 v57, 0
    v_sub_f32 v42, 0, v64
    v_mov_b32 v58, 0
    v_sub_f32 v43, 0, v64
    v_mov_b32 v59, 0
    v_sub_f32 v44, 0, v64
    v_mov_b32 v60, 0
    v_sub_f32 v45, 0, v64
    v_mov_b32 v61, 0
    v_sub_f32 v46, 0, v64
    v_mov_b32 v62, 0
    v_sub_f32 v47, 0, v64
    v_mov_b32 v63, 0
    s_mov_b32 s67, 0
L_F_p2:
    buffer_load_dwordx4 v[4:7], v249, s[40:43], s67 offen sc1
    s_mov_b64 exec, s[98:99]
    buffer_load_dwordx4 v[232:235], v250, s[44:47], s67 offen sc1
    buffer_load_dwordx4 v[236:239], v250, s[44:47], s67 offen offset:512 sc1
    s_mov_b64 exec, -1
    s_waitcnt vmcnt(0)
    v_mfma_f32_32x32x16_bf16 v[16:31], v[4:7], v[0:3], v[32:47]
    s_nop 15
    v_exp_f32 v16, v16
    v_exp_f32 v17, v17
    v_exp_f32 v18, v18
    v_exp_f32 v19, v19
    v_exp_f32 v20, v20
    v_exp_f32 v21, v21
    v_exp_f32 v22, v22
    v_exp_f32 v23, v23
    v_exp_f32 v24, v24
    v_exp_f32 v25, v25
    v_exp_f32 v26, v26
    v_exp_f32 v27, v27
    v_exp_f32 v28, v28
    v_exp_f32 v29, v29
    v_exp_f32 v30, v30
    v_exp_f32 v31, v31
    s_nop 1
    v_smfmac_f32_32x32x32_bf16 v[48:63], v[232:235], v[16:23], v248
    v_smfmac_f32_32x32x32_bf16 v[48:63], v[236:239], v[24:31], v248
    s_nop 15
    s_add_u32 s67, s67, 1024
    s_cmp_lt_u32 s67, 16384
    s_cbranch_scc1 L_F_p2
    ds_write_b128 v73, v[48:51]
    ds_write_b128 v73, v[52:55] offset:1024
    s_mov_b32 exec_hi, 0
    ds_write_b32 v74, v56
    s_mov_b32 exec_hi, -1
    v_add_u32 v72, 1024, v72
    v_add_u32 v73, 2176, v73
    v_add_u32 v74, 2176, v74
    s_add_u32 s61, s61, 1
    s_cmp_lt_u32 s61, 8
    s_cbranch_scc1 L_F_tile
    s_branch L_A_reduce
L_end:
    s_endpgm
.fill 256, 4, 0xbf810000
.section .rodata,"a"
.p2align 6
.amdhsa_kernel gated_mix__grouped_kv_mqa__dense_activation_silu__prompt_kernel
  .amdhsa_next_free_vgpr 256
  .amdhsa_next_free_sgpr 102
  .amdhsa_accum_offset 256
  .amdhsa_group_segment_fixed_size 0
  .amdhsa_kernarg_size 96
  .amdhsa_user_sgpr_count 2
  .amdhsa_user_sgpr_kernarg_segment_ptr 1
  .amdhsa_system_sgpr_workgroup_id_x 1
  .amdhsa_float_denorm_mode_32 3
.end_amdhsa_kernel
```
